```python
import torch

def _softmax(x, axis=-1):
    return torch.softmax(x, dim=axis)
def _gelu(x):
    return torch.nn.functional.gelu(x, approximate="tanh")
def _silu(x):
    return torch.nn.functional.silu(x)
def _sigmoid(x):
    return torch.sigmoid(x)
def _layernorm(x, axis=-1, eps=1e-5):
    m = x.mean(dim=axis, keepdim=True)
    v = x.var(dim=axis, keepdim=True, unbiased=False)
    return (x - m) / torch.sqrt(v + eps)
def _scatter_add(tgt, idx, src, axis=0):
    return tgt.clone().index_add_(axis, idx, src)
def _segment_sum(src, seg, n):
    out = torch.zeros((n,) + src.shape[1:], dtype=src.dtype)
    return out.index_add_(0, seg, src)
def _pad(x, pw):
    flat = tuple(v for pair in reversed(pw) for v in pair)
    return torch.nn.functional.pad(x, flat)

kernel_name = 'parallel_sum__ssm_conv_h3__dense_activation_relu__prompt'

def setup_inputs():

    _w = (lambda a: (lambda t: t.to(torch.bfloat16) if t.is_floating_point() else t)(torch.as_tensor(a)))
    def _A_setup():
        B, S, D = 1, 2048, 576
        ks = 4
        return {
            "q": _w((lambda *s: torch.randn(*s, dtype=torch.bfloat16) * 0.05)(B, S, D)),
            "k": _w((lambda *s: torch.randn(*s, dtype=torch.bfloat16) * 0.8)(B, S, D)),
            "v": _w((lambda *s: torch.randn(*s, dtype=torch.bfloat16) * 0.8)(B, S, D)),
            "shift_k": _w((lambda *s: torch.randn(*s, dtype=torch.bfloat16) * 0.8)(D, ks) * 0.5),
            "ssm_k": _w((lambda *s: torch.randn(*s, dtype=torch.bfloat16) * 0.8)(D, S) * (1.0 / S ** 0.5)),
            "ssm_D": _w((lambda *s: torch.randn(*s, dtype=torch.bfloat16) * 0.8)(D)),
        }
    _A_in = _A_setup()

    def _B_setup():
        B, S, D, Dff = 1, 2048, 576, 4608
        return {
            "x": _w((lambda *s: torch.randn(*s, dtype=torch.bfloat16) * 0.05)(B, S, D)),
            "w1": _w((lambda *s: torch.randn(*s, dtype=torch.bfloat16) * 0.05)(D, Dff)),
            "w2": _w((lambda *s: torch.randn(*s, dtype=torch.bfloat16) * 0.05)(Dff, D)),
        }
    _B_in = _B_setup()

    return {
        "A_q": _A_in["q"],
        "A_k": _A_in["k"],
        "A_v": _A_in["v"],
        "A_shift_k": _A_in["shift_k"],
        "A_ssm_k": _A_in["ssm_k"],
        "A_ssm_D": _A_in["ssm_D"],
        "B_x": _B_in["x"],
        "B_w1": _B_in["w1"],
        "B_w2": _B_in["w2"],
    }

def reference(A_q, A_k, A_v, A_shift_k, A_ssm_k, A_ssm_D, B_x, B_w1, B_w2):
    def _A_ref(q, k, v, shift_k, ssm_k, ssm_D):
        B, S, D = q.shape
        ks = shift_k.shape[-1]
        k_pad = _pad(k, ((0, 0), (ks - 1, 0), (0, 0)))
        k_shift = torch.zeros_like(k)
        for t in range(ks):
            k_shift = k_shift + k_pad[:, t:t + S, :] * shift_k[:, ks - 1 - t][None, None, :]
        kv = k_shift * v
        L = 2 * S
        kv_pad = _pad(kv, ((0, 0), (0, S), (0, 0)))
        kf_pad = _pad(ssm_k, ((0, 0), (0, S)))
        kv_f = (lambda x, axes=(-2,-1): torch.fft.rfft2(x.float(), dim=axes))(kv_pad[:, None, :, :], axes=(1, 2))
        kf_f = (lambda x, axes=(-2,-1): torch.fft.rfft2(x.float(), dim=axes))(kf_pad[:, None, :], axes=(1, 2))
        kf_f = (lambda x, *d: x.permute(*d))(kf_f, 1, 2, 0)
        y_f = kv_f * kf_f[None, :, :, :]
        y = (lambda x, s, axes=(-2,-1): torch.fft.irfft2(x, s=s, dim=axes).to(torch.bfloat16))(y_f, (1, L), axes=(1, 2))[:, 0, :S, :]
        y = y + kv * ssm_D[None, None, :]
        return q * y

    def _B_ref(x, w1, w2):
        h = torch.einsum("bsd,df->bsf", x, w1)
        zero = torch.zeros_like(h)
        h = torch.maximum(h, zero)
        return torch.einsum("bsf,fd->bsd", h, w2)

    x = A_q
    xn = _layernorm(x, axis=-1)
    return x + _A_ref(xn, A_k, A_v, A_shift_k, A_ssm_k, A_ssm_D) + _B_ref(xn, B_w1, B_w2)
```

```asm
; @launch grid=(256,1,1) block=(512,1,1) lds=163840
.amdgcn_target "amdgcn-amd-amdhsa--gfx950"
.text
.globl parallel_sum__ssm_conv_h3__dense_activation_relu__prompt_kernel
.p2align 8
.type parallel_sum__ssm_conv_h3__dense_activation_relu__prompt_kernel,@function
parallel_sum__ssm_conv_h3__dense_activation_relu__prompt_kernel:
    s_cmp_ge_u32 s2, 256
    s_cbranch_scc1 L_mexit
    s_load_dwordx16 s[4:19], s[0:1], 0
    s_load_dwordx8 s[20:27], s[0:1], 64
    v_lshrrev_b32 v1, 6, v0
    v_and_b32 v0, 63, v0
    v_readfirstlane_b32 s28, v1
    s_mov_b32 s74, 400000
    s_and_b32 s34, s2, 7
    s_lshr_b32 s35, s2, 3
    s_cmp_ge_u32 s35, 24
    s_cbranch_scc1 L_other
    s_and_b32 s48, s35, 7
    s_lshr_b32 s49, s35, 3
    s_and_b32 s29, s34, 1
    s_and_b32 s50, s48, 3
    s_mul_i32 s50, s50, 4
    s_mul_i32 s51, s29, 2
    s_add_u32 s51, s51, s50
    s_lshl_b32 s29, s29, 3
    s_add_u32 s29, s29, s48
    s_lshr_b32 s30, s34, 1
    s_mul_i32 s30, s30, 3
    s_add_u32 s30, s30, s49
    s_mul_i32 s49, s49, 0
    s_add_u32 s31, s51, s49
    s_cmp_ge_u32 s31, 18
    s_cselect_b32 s49, 18, 0
    s_sub_u32 s31, s31, s49
    s_and_b32 s33, s48, 7
    s_mul_i32 s33, s33, 1
    s_cmp_lt_u32 s28, 4
    s_cbranch_scc1 L_fcomp
    s_sub_u32 s34, s28, 4
    v_lshrrev_b32 v6, 3, v0
    v_and_b32 v7, 7, v0
    v_and_b32 v3, 6, v6
    v_xor_b32 v7, v7, v3
    v_lshlrev_b32 v7, 4, v7
    s_mul_i32 s35, s34, 18
    s_and_b32 s35, s35, 20
    v_and_b32 v3, 4, v6
    v_add3_u32 v3, v3, v6, s35
    s_movk_i32 s48, 9216
    v_mad_u32_u24 v10, v3, s48, v7
    v_lshrrev_b32 v3, 4, v0
    v_xor_b32 v4, v3, v0
    v_and_b32 v4, 7, v4
    s_lshl_b32 s35, s34, 5
    v_add_u32 v1, s35, v6
    v_mul_u32_u24 v1, 1152, v1
    v_lshl_add_u32 v12, v4, 4, v1
    v_xor_b32 v13, 64, v12
    v_add_u32 v13, s48, v13
    s_mul_i32 s50, s30, 768
    s_mul_i32 s51, s29, 147456
    s_lshl_b32 s53, s34, 10
    s_add_u32 s53, s53, 32768
    s_add_u32 s54, s53, 122880
    s_mov_b32 s55, s53
    s_lshl_b32 s56, s34, 12
    s_mov_b32 s42, 2359296
    s_mov_b32 s43, 0x20000
    s_mov_b32 s46, 5308416
    s_mov_b32 s47, 0x20000
    s_waitcnt lgkmcnt(0)
    s_mov_b64 s[40:41], s[4:5]
    s_mov_b64 s[44:45], s[18:19]
L_a0:
    s_lshl_b32 s59, s31, 6
    s_mov_b32 m0, s56
    s_add_u32 s59, s59, s51
    buffer_load_dwordx4 v12, s[40:43], s59 offen lds
    s_add_u32 m0, s56, 1024
    s_mul_i32 s58, s31, 294912
    buffer_load_dwordx4 v13, s[40:43], s59 offen lds
    s_add_u32 m0, s56, 2048
    s_add_u32 s59, s59, 18432
    buffer_load_dwordx4 v12, s[40:43], s59 offen lds
    s_add_u32 m0, s56, 3072
    s_add_u32 s58, s58, s50
    buffer_load_dwordx4 v13, s[40:43], s59 offen lds
    s_mov_b32 m0, s55
    s_xor_b32 s56, s56, 0x4000
    buffer_load_dwordx4 v10, s[44:47], s58 offen offset:0 lds
    s_add_u32 m0, s55, 3968
    s_add_u32 s31, s31, 2
    buffer_load_dwordx4 v10, s[44:47], s58 offen offset:128 lds
    s_add_u32 m0, s55, 7936
    s_nop 0
    buffer_load_dwordx4 v10, s[44:47], s58 offen offset:256 lds
    s_add_u32 m0, s55, 11904
    s_nop 0
    buffer_load_dwordx4 v10, s[44:47], s58 offen offset:384 lds
    s_add_u32 m0, s55, 15872
    s_nop 0
    buffer_load_dwordx4 v10, s[44:47], s58 offen offset:512 lds
    s_add_u32 m0, s55, 19840
    s_add_u32 s55, s55, 24576
    buffer_load_dwordx4 v10, s[44:47], s58 offen offset:640 lds
    s_cmp_eq_u32 s55, s54
    s_cselect_b32 s55, s53, s55
    s_mov_b32 m0, s55
    s_add_u32 s58, s58, 294912
    buffer_load_dwordx4 v10, s[44:47], s58 offen offset:0 lds
    s_add_u32 m0, s55, 3968
    s_nop 0
    buffer_load_dwordx4 v10, s[44:47], s58 offen offset:128 lds
    s_add_u32 m0, s55, 7936
    s_nop 0
    buffer_load_dwordx4 v10, s[44:47], s58 offen offset:256 lds
    s_add_u32 m0, s55, 11904
    s_nop 0
    buffer_load_dwordx4 v10, s[44:47], s58 offen offset:384 lds
    s_add_u32 m0, s55, 15872
    s_nop 0
    buffer_load_dwordx4 v10, s[44:47], s58 offen offset:512 lds
    s_add_u32 m0, s55, 19840
    s_add_u32 s55, s55, 24576
    buffer_load_dwordx4 v10, s[44:47], s58 offen offset:640 lds
    s_cmp_eq_u32 s55, s54
    s_cselect_b32 s55, s53, s55
    s_cmp_eq_u32 s31, 18
    s_cselect_b32 s31, 0, s31
    s_lshl_b32 s35, s34, 3
    v_add_u32 v3, s35, v6
    v_mul_u32_u24 v3, 1152, v3
    v_add_u32 v11, v3, v7
    v_mov_b32 v16, 0
    v_mov_b32 v24, 0
    s_and_b32 s48, s2, 7
    s_mul_i32 s48, s48, 24
    s_lshr_b32 s49, s2, 3
    s_add_u32 s48, s48, s49
    s_mul_i32 s49, s34, 192
    s_add_u32 s48, s48, s49
    s_lshr_b32 s15, s48, 8
    s_lshl_b32 s15, s15, 1
    s_add_u32 s15, s15, 8
    s_cmp_ge_u32 s48, 640
    s_cselect_b32 s6, 99, 0
    s_add_u32 s49, s48, 768
    s_cmp_ge_u32 s48, 640
    s_cselect_b32 s48, s49, s48
    s_cselect_b32 s6, 0, s6
    s_cselect_b32 s15, 40, s15
    v_and_b32 v1, 15, v0
    v_lshrrev_b32 v2, 4, v0
    v_mul_u32_u24 v4, 1152, v1
    v_and_b32 v5, 1, v2
    v_lshl_add_u32 v4, v5, 5, v4
    v_lshrrev_b32 v5, 1, v2
    v_lshl_add_u32 v249, v5, 4, v4
    v_lshlrev_b32 v250, 3, v1
    v_lshlrev_b32 v4, 7, v0
    v_bfrev_b32 v5, 1
    s_mov_b64 s[64:65], 1
    s_mov_b64 s[66:67], 0xff
    v_cndmask_b32 v254, v5, v4, s[66:67]
    v_cndmask_b32 v253, v5, v4, s[64:65]
    v_lshlrev_b32 v248, 4, v0
    s_mov_b32 s40, s4
    s_mov_b32 s41, s5
    s_mov_b32 s42, 2359296
    s_mov_b32 s43, 0x20000
    v_lshrrev_b32 v1, 2, v0
    v_and_b32 v2, 3, v0
    v_mul_u32_u24 v4, 1152, v1
    v_lshl_add_u32 v251, v2, 4, v4
    v_and_b32 v4, 1, v2
    v_lshl_add_u32 v1, v4, 5, v1
    v_lshrrev_b32 v4, 1, v2
    v_lshl_add_u32 v1, v4, 4, v1
    v_lshlrev_b32 v252, 2, v1
    s_mov_b32 s35, 0xffff0000
    s_mov_b32 s60, s22
    s_mov_b32 s61, s23
    s_mov_b32 s62, 2359296
    s_mov_b32 s63, 0x20000
    s_mov_b32 s36, s26
    s_mov_b32 s37, s27
    s_mov_b32 s38, 33193728
    s_mov_b32 s39, 0x20000
    s_lshr_b32 s13, s48, 8
    s_bfe_u32 s64, s48, 0x70001
    s_and_b32 s65, s48, 1
    s_lshr_b32 s66, s64, 3
    s_and_b32 s66, s66, 7
    s_mul_i32 s66, s66, 1
    s_add_u32 s66, s66, s13
    s_cmp_ge_u32 s66, 9
    s_cselect_b32 s67, 9, 0
    s_sub_u32 s66, s66, s67
    s_lshr_b32 s67, s64, 1
    s_lshl_b32 s12, s67, 7
    s_mul_i32 s67, s67, 9
    s_add_u32 s67, s67, s66
    s_lshl_b32 s67, s67, 12
    s_and_b32 s11, s48, 3
    s_lshl_b32 s11, s11, 10
    s_mul_i32 s8, s67, 12
    s_add_u32 s8, s8, s11
    s_lshl_b32 s9, s65, 11
    s_add_u32 s9, s9, s67
    s_add_u32 s9, s9, 28311552
    s_lshl_b32 s66, s66, 1
    s_add_u32 s66, s66, s65
    s_mul_i32 s10, s64, 18432
    s_lshl_b32 s67, s66, 6
    s_add_u32 s10, s10, s67
    s_lshl_b32 s11, s64, 7
    s_add_u32 s11, s11, 30707712
    s_add_u32 s67, s13, 1
    s_mul_i32 s67, s67, 8192
    s_add_u32 s12, s12, s67
    s_add_u32 s12, s12, 30732800
    s_bitcmp1_b32 s48, 1
    s_cselect_b32 s13, 0x02020000, 0
    s_add_u32 s13, s13, 0x01000c0c
    s_lshr_b32 s67, s66, 1
    s_sub_u32 s66, s66, 8
    s_max_i32 s66, s66, s67
    s_lshl_b32 s14, s66, 10
    s_add_u32 s14, s14, 30822912
    s_mul_i32 s58, s30, 3072
    s_lshl_b32 s59, s34, 10
    s_add_u32 s58, s58, s59
    s_add_u32 s66, s59, 155648
    s_lshl_b32 s59, s29, 9
    s_add_u32 s59, s59, 53248
    s_cmp_eq_u32 s34, 3
    s_cselect_b32 s65, s59, s58
    s_add_u32 s65, s65, 30670848
    s_mov_b32 s7, 0
    s_mov_b32 s49, s6
    s_mov_b32 s57, 7
L_a1w:
    s_waitcnt vmcnt(6)
    s_barrier
    s_cmp_lg_u32 s57, 0
    s_cbranch_scc1 L_a1f
    global_load_dword v17, v16, s[24:25] offset:128 sc1
L_a1f:
    s_lshl_b32 s59, s31, 6
    s_mov_b32 m0, s56
    s_add_u32 s59, s59, s51
    buffer_load_dwordx4 v12, s[40:43], s59 offen lds
    s_add_u32 m0, s56, 1024
    s_mul_i32 s58, s31, 294912
    buffer_load_dwordx4 v13, s[40:43], s59 offen lds
    s_add_u32 m0, s56, 2048
    s_add_u32 s59, s59, 18432
    buffer_load_dwordx4 v12, s[40:43], s59 offen lds
    s_add_u32 m0, s56, 3072
    s_add_u32 s58, s58, s50
    buffer_load_dwordx4 v13, s[40:43], s59 offen lds
    s_mov_b32 m0, s55
    s_xor_b32 s56, s56, 0x4000
    buffer_load_dwordx4 v10, s[44:47], s58 offen offset:0 lds
    s_add_u32 m0, s55, 3968
    s_add_u32 s31, s31, 2
    buffer_load_dwordx4 v10, s[44:47], s58 offen offset:128 lds
    s_add_u32 m0, s55, 7936
    s_nop 0
    buffer_load_dwordx4 v10, s[44:47], s58 offen offset:256 lds
    s_add_u32 m0, s55, 11904
    s_nop 0
    buffer_load_dwordx4 v10, s[44:47], s58 offen offset:384 lds
    s_add_u32 m0, s55, 15872
    s_nop 0
    buffer_load_dwordx4 v10, s[44:47], s58 offen offset:512 lds
    s_add_u32 m0, s55, 19840
    s_add_u32 s55, s55, 24576
    buffer_load_dwordx4 v10, s[44:47], s58 offen offset:640 lds
    s_cmp_eq_u32 s55, s54
    s_cselect_b32 s55, s53, s55
    s_waitcnt vmcnt(10)
    s_barrier
    s_cmp_lg_u32 s57, 0
    s_cbranch_scc1 L_a1i
L_a1p:
    v_cmp_ne_u32 vcc, 0, v17
    s_nop 0
    s_cmp_eq_u64 vcc, -1
    s_cbranch_scc1 L_a1g
    global_load_dword v17, v16, s[24:25] offset:128 sc1
    s_waitcnt vmcnt(0)
    s_sub_u32 s74, s74, 1
    s_cbranch_scc0 L_a1p
    s_mov_b32 s74, 0
L_a1g:
    s_mov_b32 m0, s66
    s_nop 0
    buffer_load_dwordx4 v248, s[36:39], s65 offen sc1 lds
L_a1i:
    s_mov_b32 m0, s55
    s_add_u32 s58, s58, 294912
    buffer_load_dwordx4 v10, s[44:47], s58 offen offset:0 lds
    s_add_u32 m0, s55, 3968
    s_nop 0
    buffer_load_dwordx4 v10, s[44:47], s58 offen offset:128 lds
    s_add_u32 m0, s55, 7936
    s_nop 0
    buffer_load_dwordx4 v10, s[44:47], s58 offen offset:256 lds
    s_add_u32 m0, s55, 11904
    s_nop 0
    buffer_load_dwordx4 v10, s[44:47], s58 offen offset:384 lds
    s_add_u32 m0, s55, 15872
    s_nop 0
    buffer_load_dwordx4 v10, s[44:47], s58 offen offset:512 lds
    s_add_u32 m0, s55, 19840
    s_add_u32 s55, s55, 24576
    buffer_load_dwordx4 v10, s[44:47], s58 offen offset:640 lds
    s_cmp_eq_u32 s55, s54
    s_cselect_b32 s55, s53, s55
    s_cmp_eq_u32 s31, 18
    s_cselect_b32 s31, 0, s31
    s_sub_u32 s57, s57, 1
    s_cbranch_scc0 L_a1w
    s_mov_b64 s[44:45], s[20:21]
    s_mul_i32 s50, s30, 442368
    s_mov_b32 s52, s33
    s_mov_b32 s57, 0
L_a2:
    s_lshl_b32 s58, s52, 7
    s_add_u32 s58, s58, s50
    s_cmp_lg_u32 s57, 1
    s_cbranch_scc1 L_a2t
    s_waitcnt vmcnt(6)
L_a2t:
    s_cmp_lg_u32 s57, 0
    s_cbranch_scc1 L_a2m0
    s_waitcnt vmcnt(7)
L_a2m0:
    s_waitcnt vmcnt(12)
    s_barrier
    s_sub_u32 s15, s15, 1
    s_cmp_ge_i32 s15, 0
    s_cbranch_scc1 L_ich0
    s_cmp_lg_u32 s49, 0
    s_cbranch_scc1 L_ich0
    s_waitcnt vmcnt(12)
    v_readfirstlane_b32 s3, v24
    s_nop 0
    s_cmp_ge_u32 s3, 12
    s_cselect_b32 s49, 1, 0
    s_cbranch_scc1 L_ich0
    v_mov_b32 v24, 0
    buffer_atomic_add v24, v253, s[36:39], s12 offen sc0 sc1
L_ich0:
    s_add_u32 m0, s55, 0
    s_nop 0
    buffer_load_dwordx4 v11, s[44:47], s58 offen lds
    s_add_u32 s58, s58, 36864
    s_add_u32 m0, s55, 4096
    s_nop 0
    buffer_load_dwordx4 v11, s[44:47], s58 offen lds
    s_add_u32 s58, s58, 36864
    s_add_u32 m0, s55, 8192
    s_nop 0
    buffer_load_dwordx4 v11, s[44:47], s58 offen lds
    s_add_u32 s58, s58, 36864
    s_add_u32 m0, s55, 12288
    s_nop 0
    buffer_load_dwordx4 v11, s[44:47], s58 offen lds
    s_add_u32 s58, s58, 36864
    s_add_u32 m0, s55, 16384
    s_nop 0
    buffer_load_dwordx4 v11, s[44:47], s58 offen lds
    s_add_u32 s58, s58, 36864
    s_add_u32 m0, s55, 20480
    s_nop 0
    buffer_load_dwordx4 v11, s[44:47], s58 offen lds
    s_add_u32 s58, s58, 36864
    s_add_u32 s55, s55, 24576
    s_cmp_eq_u32 s55, s54
    s_cselect_b32 s55, s53, s55
    s_cmp_lg_u32 s49, 1
    s_cbranch_scc1 L_iih00
    buffer_load_dwordx4 v[80:83], v248, s[36:39], s8 offen sc1
    s_add_u32 s8, s8, 4096
    buffer_load_dwordx4 v[84:87], v248, s[36:39], s8 offen sc1
    s_add_u32 s8, s8, 4096
    buffer_load_dwordx4 v[88:91], v248, s[36:39], s8 offen sc1
    s_add_u32 s8, s8, 4096
    buffer_load_dwordx4 v[92:95], v248, s[36:39], s8 offen sc1
    s_add_u32 s8, s8, 4096
    buffer_load_dwordx4 v[96:99], v248, s[36:39], s8 offen sc1
    s_add_u32 s8, s8, 4096
    buffer_load_dwordx4 v[100:103], v248, s[36:39], s8 offen sc1
    s_add_u32 s8, s8, 4096
    s_mov_b32 s49, 2
    s_branch L_ijh0
L_iih00:
    s_cmp_lg_u32 s49, 2
    s_cbranch_scc1 L_iih01
    buffer_load_dwordx4 v[104:107], v248, s[36:39], s8 offen sc1
    s_add_u32 s8, s8, 4096
    buffer_load_dwordx4 v[108:111], v248, s[36:39], s8 offen sc1
    s_add_u32 s8, s8, 4096
    buffer_load_dwordx4 v[112:115], v248, s[36:39], s8 offen sc1
    s_add_u32 s8, s8, 4096
    buffer_load_dwordx4 v[116:119], v248, s[36:39], s8 offen sc1
    s_add_u32 s8, s8, 4096
    buffer_load_dwordx4 v[120:123], v248, s[36:39], s8 offen sc1
    s_add_u32 s8, s8, 4096
    buffer_load_dwordx4 v[124:127], v248, s[36:39], s8 offen sc1
    s_add_u32 s8, s8, 4096
    s_mov_b32 s49, 3
    s_branch L_ijh0
L_iih01:
L_ijh0:
    s_cmp_eq_u32 s57, 1
    s_cbranch_scc1 L_a2s
    s_cmp_lg_u32 s57, 0
    s_cbranch_scc1 L_a2m1
    s_waitcnt vmcnt(6)
L_a2m1:
    s_waitcnt vmcnt(12)
    s_barrier
L_a2s:
    s_sub_u32 s15, s15, 1
    s_add_u32 m0, s55, 0
    s_nop 0
    buffer_load_dwordx4 v11, s[44:47], s58 offen lds
    s_add_u32 s58, s58, 36864
    s_add_u32 m0, s55, 4096
    s_nop 0
    buffer_load_dwordx4 v11, s[44:47], s58 offen lds
    s_add_u32 s58, s58, 36864
    s_add_u32 m0, s55, 8192
    s_nop 0
    buffer_load_dwordx4 v11, s[44:47], s58 offen lds
    s_add_u32 s58, s58, 36864
    s_add_u32 m0, s55, 12288
    s_nop 0
    buffer_load_dwordx4 v11, s[44:47], s58 offen lds
    s_add_u32 s58, s58, 36864
    s_add_u32 m0, s55, 16384
    s_nop 0
    buffer_load_dwordx4 v11, s[44:47], s58 offen lds
    s_add_u32 s58, s58, 36864
    s_add_u32 m0, s55, 20480
    s_nop 0
    buffer_load_dwordx4 v11, s[44:47], s58 offen lds
    s_add_u32 s58, s58, 36864
    s_add_u32 s55, s55, 24576
    s_cmp_eq_u32 s55, s54
    s_cselect_b32 s55, s53, s55
    s_cmp_lg_u32 s49, 1
    s_cbranch_scc1 L_iih10
    buffer_load_dwordx4 v[80:83], v248, s[36:39], s8 offen sc1
    s_add_u32 s8, s8, 4096
    buffer_load_dwordx4 v[84:87], v248, s[36:39], s8 offen sc1
    s_add_u32 s8, s8, 4096
    buffer_load_dwordx4 v[88:91], v248, s[36:39], s8 offen sc1
    s_add_u32 s8, s8, 4096
    buffer_load_dwordx4 v[92:95], v248, s[36:39], s8 offen sc1
    s_add_u32 s8, s8, 4096
    buffer_load_dwordx4 v[96:99], v248, s[36:39], s8 offen sc1
    s_add_u32 s8, s8, 4096
    buffer_load_dwordx4 v[100:103], v248, s[36:39], s8 offen sc1
    s_add_u32 s8, s8, 4096
    s_mov_b32 s49, 2
    s_branch L_ijh1
L_iih10:
    s_cmp_lg_u32 s49, 2
    s_cbranch_scc1 L_iih11
    buffer_load_dwordx4 v[104:107], v248, s[36:39], s8 offen sc1
    s_add_u32 s8, s8, 4096
    buffer_load_dwordx4 v[108:111], v248, s[36:39], s8 offen sc1
    s_add_u32 s8, s8, 4096
    buffer_load_dwordx4 v[112:115], v248, s[36:39], s8 offen sc1
    s_add_u32 s8, s8, 4096
    buffer_load_dwordx4 v[116:119], v248, s[36:39], s8 offen sc1
    s_add_u32 s8, s8, 4096
    buffer_load_dwordx4 v[120:123], v248, s[36:39], s8 offen sc1
    s_add_u32 s8, s8, 4096
    buffer_load_dwordx4 v[124:127], v248, s[36:39], s8 offen sc1
    s_add_u32 s8, s8, 4096
    s_mov_b32 s49, 3
    s_branch L_ijh1
L_iih11:
L_ijh1:
    s_add_u32 s52, s52, 1
    s_cmp_eq_u32 s52, 9
    s_cselect_b32 s52, 0, s52
    s_add_u32 s57, s57, 1
    s_cmp_lg_u32 s57, 2
    s_cbranch_scc1 L_a2k
    buffer_load_dwordx4 v[232:235], v249, s[40:43], s10 offen
    buffer_load_dwordx2 v[236:237], v250, s[36:39], s11 offen sc1
L_a2k:
    s_cmp_lt_u32 s57, 9
    s_cbranch_scc1 L_a2
    s_mov_b32 s75, 2
    s_waitcnt vmcnt(12)
    s_barrier
    s_waitcnt vmcnt(0)
    s_mov_b32 s57, 2
L_a3:
    s_sub_u32 s15, s15, 1
    s_cmp_ge_i32 s15, 0
    s_cbranch_scc1 L_ict
    s_cmp_lg_u32 s49, 0
    s_cbranch_scc1 L_ict
    s_waitcnt vmcnt(0)
    v_readfirstlane_b32 s3, v24
    s_nop 0
    s_cmp_ge_u32 s3, 12
    s_cselect_b32 s49, 1, 0
    s_cbranch_scc1 L_ict
    v_mov_b32 v24, 0
    buffer_atomic_add v24, v253, s[36:39], s12 offen sc0 sc1
L_ict:
L_arest:
    s_cmp_lg_u32 s49, 1
    s_cbranch_scc1 L_iit0
    buffer_load_dwordx4 v[80:83], v248, s[36:39], s8 offen sc1
    s_add_u32 s8, s8, 4096
    buffer_load_dwordx4 v[84:87], v248, s[36:39], s8 offen sc1
    s_add_u32 s8, s8, 4096
    buffer_load_dwordx4 v[88:91], v248, s[36:39], s8 offen sc1
    s_add_u32 s8, s8, 4096
    buffer_load_dwordx4 v[92:95], v248, s[36:39], s8 offen sc1
    s_add_u32 s8, s8, 4096
    buffer_load_dwordx4 v[96:99], v248, s[36:39], s8 offen sc1
    s_add_u32 s8, s8, 4096
    buffer_load_dwordx4 v[100:103], v248, s[36:39], s8 offen sc1
    s_add_u32 s8, s8, 4096
    s_mov_b32 s49, 2
    s_branch L_ijt
L_iit0:
    s_cmp_lg_u32 s49, 2
    s_cbranch_scc1 L_iit1
    buffer_load_dwordx4 v[104:107], v248, s[36:39], s8 offen sc1
    s_add_u32 s8, s8, 4096
    buffer_load_dwordx4 v[108:111], v248, s[36:39], s8 offen sc1
    s_add_u32 s8, s8, 4096
    buffer_load_dwordx4 v[112:115], v248, s[36:39], s8 offen sc1
    s_add_u32 s8, s8, 4096
    buffer_load_dwordx4 v[116:119], v248, s[36:39], s8 offen sc1
    s_add_u32 s8, s8, 4096
    buffer_load_dwordx4 v[120:123], v248, s[36:39], s8 offen sc1
    s_add_u32 s8, s8, 4096
    buffer_load_dwordx4 v[124:127], v248, s[36:39], s8 offen sc1
    s_add_u32 s8, s8, 4096
    s_mov_b32 s49, 3
    s_branch L_ijt
L_iit1:
L_ijt:
    s_cmp_lt_i32 s57, 0
    s_cbranch_scc1 L_a4
    s_barrier
    s_sub_u32 s57, s57, 1
    s_cbranch_scc0 L_a3
    s_cmp_eq_u32 s49, 0
    s_cbranch_scc1 L_late
L_a4:
    s_cmp_le_u32 s49, 2
    s_cbranch_scc1 L_arest
    s_cmp_eq_u32 s49, 99
    s_cbranch_scc1 L_rlx
    s_branch L_rl3
.p2align 12
.fill 0, 4, 0xbf800000
L_fcomp:
    s_cmp_lg_u32 s28, 0
    s_cbranch_scc1 L_fnp
    s_getpc_b64 s[68:69]
L_pf_L_a0:
    s_sub_u32 s68, s68, L_pf_L_a0-L_a0
    s_subb_u32 s69, s69, 0
    v_lshlrev_b32 v200, 7, v0
    s_and_b32 s70, s29, 3
    s_lshl_b32 s70, s70, 13
    v_add_u32 v200, s70, v200
    s_mov_b32 s70, L_other-L_a0
    v_min_u32 v201, s70, v200
    v_mov_b32 v203, s69
    v_add_co_u32 v202, vcc, s68, v201
    s_nop 1
    v_addc_co_u32 v203, vcc, 0, v203, vcc
    global_load_dword v204, v[202:203], off
L_fnp:
    s_setprio 1
    v_lshrrev_b32 v1, 4, v0
    v_and_b32 v2, 15, v0
    v_lshrrev_b32 v3, 2, v2
    v_and_b32 v4, 1, v1
    v_lshl_add_u32 v4, v4, 2, v3
    v_lshrrev_b32 v5, 1, v1
    v_lshlrev_b32 v5, 10, v5
    v_lshl_add_u32 v5, v4, 7, v5
    v_and_b32 v6, 3, v2
    v_lshl_add_u32 v5, v6, 3, v5
    v_add_u32 v5, 32768, v5
    v_lshrrev_b32 v4, 1, v4
    v_xor_b32 v6, 0, v4
    v_lshl_add_u32 v48, v6, 5, v5
    v_xor_b32 v6, 1, v4
    v_lshl_add_u32 v49, v6, 5, v5
    v_xor_b32 v6, 2, v4
    v_lshl_add_u32 v50, v6, 5, v5
    v_xor_b32 v6, 3, v4
    v_lshl_add_u32 v51, v6, 5, v5
    v_lshrrev_b32 v4, 1, v2
    v_xor_b32 v4, v4, v1
    v_lshlrev_b32 v4, 4, v4
    v_lshl_add_u32 v4, v2, 7, v4
    s_lshl_b32 s34, s28, 12
    v_add_u32 v52, s34, v4
    v_lshlrev_b32 v59, 4, v2
    v_add_u32 v59, 155648, v59
    s_lshl_b32 s34, s28, 7
    s_add_u32 s34, s34, 158720
    v_lshl_add_u32 v7, v2, 2, s34
    v_lshlrev_b32 v4, 2, v0
    v_add_u32 v4, 159744, v4
    v_mov_b32 v5, 0
    ds_write2_b32 v4, v5, v5 offset0:0 offset1:16
    v_lshlrev_b32 v58, 4, v0
    v_cmp_gt_u32 vcc, 16, v0
    s_mov_b32 s40, 4
    s_mov_b32 s42, 24576
    v_cndmask_b32 v7, v4, v7, vcc
    s_mov_b32 s43, -98304
    s_lshl_b32 s45, s29, 2
    s_add_u32 s45, s45, s28
    s_mul_i32 s45, s45, 108
    s_add_u32 s45, s45, s30
    s_lshl_b32 s45, s45, 12
    s_add_u32 s46, s45, 442368
    s_mul_i32 s44, s33, 49152
    s_add_u32 s44, s44, s45
    s_mov_b32 s47, 7
    v_cmp_eq_u32 vcc, 0, v0
    v_bfrev_b32 v6, 1
    s_lshl_b32 s48, s29, 2
    v_cndmask_b32 v6, v6, 0, vcc
    v_mov_b32 v1, 1
    s_add_u32 s48, s48, s28
    s_lshl_b32 s48, s48, 7
    s_add_u32 s48, s48, 30732800
    s_waitcnt lgkmcnt(0)
    s_mov_b32 s36, s26
    s_mov_b32 s37, s27
    s_mov_b32 s38, 33193728
    s_mov_b32 s39, 0x20000
    s_and_b32 s50, s2, 7
    s_mul_i32 s50, s50, 24
    s_lshr_b32 s51, s2, 3
    s_add_u32 s50, s50, s51
    s_lshl_b32 s50, s50, 1
    s_lshr_b32 s51, s28, 1
    s_add_u32 s50, s50, s51
    s_mul_hi_u32 s51, s50, 1431655766
    s_mul_i32 s52, s51, 3
    s_sub_u32 s50, s50, s52
    s_add_u32 s50, s50, 6
    s_lshl_b32 s50, s50, 8
    s_lshl_b32 s51, s51, 1
    s_add_u32 s50, s50, s51
    s_and_b32 s51, s28, 1
    s_add_u32 s50, s50, s51
    s_lshr_b32 s13, s50, 8
    s_bfe_u32 s64, s50, 0x70001
    s_and_b32 s65, s50, 1
    s_lshr_b32 s66, s64, 3
    s_and_b32 s66, s66, 7
    s_mul_i32 s66, s66, 1
    s_add_u32 s66, s66, s13
    s_cmp_ge_u32 s66, 9
    s_cselect_b32 s67, 9, 0
    s_sub_u32 s66, s66, s67
    s_lshr_b32 s67, s64, 1
    s_lshl_b32 s12, s67, 7
    s_mul_i32 s67, s67, 9
    s_add_u32 s67, s67, s66
    s_lshl_b32 s67, s67, 12
    s_and_b32 s11, s50, 3
    s_lshl_b32 s11, s11, 10
    s_mul_i32 s8, s67, 12
    s_add_u32 s8, s8, s11
    s_lshl_b32 s9, s65, 11
    s_add_u32 s9, s9, s67
    s_add_u32 s9, s9, 28311552
    s_lshl_b32 s66, s66, 1
    s_add_u32 s66, s66, s65
    s_mul_i32 s10, s64, 18432
    s_lshl_b32 s67, s66, 6
    s_add_u32 s10, s10, s67
    s_lshl_b32 s11, s64, 7
    s_add_u32 s11, s11, 30707712
    s_add_u32 s67, s13, 1
    s_mul_i32 s67, s67, 8192
    s_add_u32 s12, s12, s67
    s_add_u32 s12, s12, 30732800
    s_bitcmp1_b32 s50, 1
    s_cselect_b32 s13, 0x02020000, 0
    s_add_u32 s13, s13, 0x01000c0c
    s_lshr_b32 s67, s66, 1
    s_sub_u32 s66, s66, 8
    s_max_i32 s66, s66, s67
    s_lshl_b32 s14, s66, 10
    s_add_u32 s14, s14, 30822912
    s_mov_b32 s7, 0
    s_mul_i32 s50, s7, 8192
    s_add_u32 s12, s12, s50
    s_mov_b32 s75, 1
    s_mov_b64 vcc, 1
    s_sub_u32 s60, s28, 4
L_wret:
    s_add_u32 s60, s60, 4
    s_cmp_eq_u32 s60, 0
    s_cbranch_scc1 L_pad0
    s_cmp_eq_u32 s60, 1
    s_cbranch_scc1 L_pad1
    s_cmp_eq_u32 s60, 2
    s_cbranch_scc1 L_pad2
    s_mov_b64 vcc, 0
    s_waitcnt vmcnt(0)
    s_barrier
    ds_read_b64_tr_b16 v[24:25], v48 offset:0
    ds_read_b128 v[8:11], v52 offset:0
    ds_read_b64_tr_b16 v[26:27], v48 offset:2048
    ds_read_b64_tr_b16 v[28:29], v49 offset:0
    ds_read_b128 v[12:15], v52 offset:2048
    ds_read_b64_tr_b16 v[30:31], v49 offset:2048
    ds_read_b64_tr_b16 v[32:33], v50 offset:0
    ds_read_b64_tr_b16 v[34:35], v50 offset:2048
    ds_read_b64_tr_b16 v[36:37], v51 offset:0
    ds_read_b64_tr_b16 v[38:39], v51 offset:2048
    ds_read_b64_tr_b16 v[40:41], v48 offset:4096
    ds_read_b64_tr_b16 v[42:43], v48 offset:6144
    s_waitcnt lgkmcnt(9)
    v_mfma_f32_16x16x32_bf16 v[64:67], v[24:27], v[8:11], 0
    ds_read_b64_tr_b16 v[44:45], v49 offset:4096
    s_waitcnt lgkmcnt(8)
    v_mfma_f32_16x16x32_bf16 v[68:71], v[24:27], v[12:15], 0
    ds_read_b64_tr_b16 v[46:47], v49 offset:6144
    s_waitcnt lgkmcnt(8)
    v_mfma_f32_16x16x32_bf16 v[72:75], v[28:31], v[8:11], 0
    ds_read_b64_tr_b16 v[24:25], v50 offset:4096
    v_xor_b32 v52, 64, v52
    v_mfma_f32_16x16x32_bf16 v[76:79], v[28:31], v[12:15], 0
    ds_read_b64_tr_b16 v[26:27], v50 offset:6144
    s_waitcnt lgkmcnt(8)
    v_mfma_f32_16x16x32_bf16 v[80:83], v[32:35], v[8:11], 0
    ds_read_b64_tr_b16 v[28:29], v51 offset:4096
    v_mfma_f32_16x16x32_bf16 v[84:87], v[32:35], v[12:15], 0
    ds_read_b64_tr_b16 v[30:31], v51 offset:6144
    s_waitcnt lgkmcnt(8)
    v_mfma_f32_16x16x32_bf16 v[88:91], v[36:39], v[8:11], 0
    ds_read_b64_tr_b16 v[32:33], v48 offset:8192
    v_mfma_f32_16x16x32_bf16 v[92:95], v[36:39], v[12:15], 0
    ds_read_b64_tr_b16 v[34:35], v48 offset:10240
    s_waitcnt lgkmcnt(8)
    v_mfma_f32_16x16x32_bf16 v[96:99], v[40:43], v[8:11], 0
    ds_read_b64_tr_b16 v[36:37], v49 offset:8192
    v_mfma_f32_16x16x32_bf16 v[100:103], v[40:43], v[12:15], 0
    ds_read_b64_tr_b16 v[38:39], v49 offset:10240
    s_waitcnt lgkmcnt(8)
    v_mfma_f32_16x16x32_bf16 v[104:107], v[44:47], v[8:11], 0
    ds_read_b64_tr_b16 v[40:41], v50 offset:8192
    v_mfma_f32_16x16x32_bf16 v[108:111], v[44:47], v[12:15], 0
    ds_read_b64_tr_b16 v[42:43], v50 offset:10240
    s_waitcnt lgkmcnt(8)
    v_mfma_f32_16x16x32_bf16 v[112:115], v[24:27], v[8:11], 0
    ds_read_b64_tr_b16 v[44:45], v51 offset:8192
    v_mfma_f32_16x16x32_bf16 v[116:119], v[24:27], v[12:15], 0
    ds_read_b64_tr_b16 v[46:47], v51 offset:10240
    s_waitcnt lgkmcnt(8)
    v_mfma_f32_16x16x32_bf16 v[120:123], v[28:31], v[8:11], 0
    ds_read_b64_tr_b16 v[24:25], v48 offset:12288
    v_mfma_f32_16x16x32_bf16 v[124:127], v[28:31], v[12:15], 0
    ds_read_b64_tr_b16 v[26:27], v48 offset:14336
    s_waitcnt lgkmcnt(8)
    v_mfma_f32_16x16x32_bf16 v[128:131], v[32:35], v[8:11], 0
    ds_read_b64_tr_b16 v[28:29], v49 offset:12288
    v_mfma_f32_16x16x32_bf16 v[132:135], v[32:35], v[12:15], 0
    ds_read_b64_tr_b16 v[30:31], v49 offset:14336
    s_waitcnt lgkmcnt(8)
    v_mfma_f32_16x16x32_bf16 v[136:139], v[36:39], v[8:11], 0
    ds_read_b64_tr_b16 v[32:33], v50 offset:12288
    v_mfma_f32_16x16x32_bf16 v[140:143], v[36:39], v[12:15], 0
    ds_read_b64_tr_b16 v[34:35], v50 offset:14336
    s_waitcnt lgkmcnt(8)
    v_mfma_f32_16x16x32_bf16 v[144:147], v[40:43], v[8:11], 0
    ds_read_b64_tr_b16 v[36:37], v51 offset:12288
    v_mfma_f32_16x16x32_bf16 v[148:151], v[40:43], v[12:15], 0
    ds_read_b64_tr_b16 v[38:39], v51 offset:14336
    s_waitcnt lgkmcnt(8)
    v_mfma_f32_16x16x32_bf16 v[152:155], v[44:47], v[8:11], 0
    ds_read_b64_tr_b16 v[40:41], v48 offset:16384
    v_mfma_f32_16x16x32_bf16 v[156:159], v[44:47], v[12:15], 0
    ds_read_b64_tr_b16 v[42:43], v48 offset:18432
    s_waitcnt lgkmcnt(8)
    v_mfma_f32_16x16x32_bf16 v[160:163], v[24:27], v[8:11], 0
    ds_read_b64_tr_b16 v[44:45], v49 offset:16384
    v_mfma_f32_16x16x32_bf16 v[164:167], v[24:27], v[12:15], 0
    ds_read_b64_tr_b16 v[46:47], v49 offset:18432
    s_waitcnt lgkmcnt(8)
    v_mfma_f32_16x16x32_bf16 v[168:171], v[28:31], v[8:11], 0
    ds_read_b64_tr_b16 v[24:25], v50 offset:16384
    s_sub_u32 s40, s40, 1
    v_mfma_f32_16x16x32_bf16 v[172:175], v[28:31], v[12:15], 0
    ds_read_b64_tr_b16 v[26:27], v50 offset:18432
    s_waitcnt lgkmcnt(8)
    v_mfma_f32_16x16x32_bf16 v[176:179], v[32:35], v[8:11], 0
    ds_read_b64_tr_b16 v[28:29], v51 offset:16384
    s_cselect_b32 s41, s43, s42
    v_mfma_f32_16x16x32_bf16 v[180:183], v[32:35], v[12:15], 0
    ds_read_b64_tr_b16 v[30:31], v51 offset:18432
    s_waitcnt lgkmcnt(8)
    v_mfma_f32_16x16x32_bf16 v[184:187], v[36:39], v[8:11], 0
    ds_read_b64_tr_b16 v[32:33], v48 offset:20480
    s_cselect_b32 s40, 4, s40
    v_mfma_f32_16x16x32_bf16 v[188:191], v[36:39], v[12:15], 0
    ds_read_b64_tr_b16 v[34:35], v48 offset:22528
    s_waitcnt lgkmcnt(8)
    v_mfma_f32_16x16x32_bf16 v[192:195], v[40:43], v[8:11], 0
    ds_read_b64_tr_b16 v[36:37], v49 offset:20480
    v_add_u32 v48, s41, v48
    v_mfma_f32_16x16x32_bf16 v[196:199], v[40:43], v[12:15], 0
    ds_read_b64_tr_b16 v[38:39], v49 offset:22528
    s_waitcnt lgkmcnt(8)
    v_mfma_f32_16x16x32_bf16 v[200:203], v[44:47], v[8:11], 0
    ds_read_b64_tr_b16 v[40:41], v50 offset:20480
    v_add_u32 v49, s41, v49
    v_mfma_f32_16x16x32_bf16 v[204:207], v[44:47], v[12:15], 0
    ds_read_b64_tr_b16 v[42:43], v50 offset:22528
    s_waitcnt lgkmcnt(8)
    v_mfma_f32_16x16x32_bf16 v[208:211], v[24:27], v[8:11], 0
    ds_read_b64_tr_b16 v[44:45], v51 offset:20480
    v_add_u32 v50, s41, v50
    v_mfma_f32_16x16x32_bf16 v[212:215], v[24:27], v[12:15], 0
    ds_read_b64_tr_b16 v[46:47], v51 offset:22528
    s_waitcnt lgkmcnt(8)
    v_mfma_f32_16x16x32_bf16 v[216:219], v[28:31], v[8:11], 0
    s_barrier
    ds_read_b64_tr_b16 v[24:25], v48 offset:0
    ds_read_b128 v[16:19], v52 offset:0
    v_mfma_f32_16x16x32_bf16 v[220:223], v[28:31], v[12:15], 0
    ds_read_b64_tr_b16 v[26:27], v48 offset:2048
    s_waitcnt lgkmcnt(9)
    v_mfma_f32_16x16x32_bf16 v[224:227], v[32:35], v[8:11], 0
    ds_read_b64_tr_b16 v[28:29], v49 offset:0
    ds_read_b128 v[20:23], v52 offset:2048
    v_mfma_f32_16x16x32_bf16 v[228:231], v[32:35], v[12:15], 0
    ds_read_b64_tr_b16 v[30:31], v49 offset:2048
    s_waitcnt lgkmcnt(10)
    v_mfma_f32_16x16x32_bf16 v[232:235], v[36:39], v[8:11], 0
    ds_read_b64_tr_b16 v[32:33], v50 offset:0
    v_add_u32 v51, s41, v51
    v_mfma_f32_16x16x32_bf16 v[236:239], v[36:39], v[12:15], 0
    ds_read_b64_tr_b16 v[34:35], v50 offset:2048
    s_waitcnt lgkmcnt(10)
    v_mfma_f32_16x16x32_bf16 v[240:243], v[40:43], v[8:11], 0
    ds_read_b64_tr_b16 v[36:37], v51 offset:0
    v_mfma_f32_16x16x32_bf16 v[244:247], v[40:43], v[12:15], 0
    ds_read_b64_tr_b16 v[38:39], v51 offset:2048
    s_waitcnt lgkmcnt(10)
    v_mfma_f32_16x16x32_bf16 v[248:251], v[44:47], v[8:11], 0
    ds_read_b64_tr_b16 v[40:41], v48 offset:4096
    v_mfma_f32_16x16x32_bf16 v[252:255], v[44:47], v[12:15], 0
    ds_read_b64_tr_b16 v[42:43], v48 offset:6144
L_g1:
    s_waitcnt lgkmcnt(9)
    v_mfma_f32_16x16x32_bf16 v[64:67], v[24:27], v[16:19], v[64:67]
    ds_read_b64_tr_b16 v[44:45], v49 offset:4096
    s_waitcnt lgkmcnt(8)
    v_mfma_f32_16x16x32_bf16 v[68:71], v[24:27], v[20:23], v[68:71]
    ds_read_b64_tr_b16 v[46:47], v49 offset:6144
    s_waitcnt lgkmcnt(8)
    v_mfma_f32_16x16x32_bf16 v[72:75], v[28:31], v[16:19], v[72:75]
    ds_read_b64_tr_b16 v[24:25], v50 offset:4096
    v_xor_b32 v52, 0x4040, v52
    v_mfma_f32_16x16x32_bf16 v[76:79], v[28:31], v[20:23], v[76:79]
    ds_read_b64_tr_b16 v[26:27], v50 offset:6144
    s_waitcnt lgkmcnt(8)
    v_mfma_f32_16x16x32_bf16 v[80:83], v[32:35], v[16:19], v[80:83]
    ds_read_b64_tr_b16 v[28:29], v51 offset:4096
    v_mfma_f32_16x16x32_bf16 v[84:87], v[32:35], v[20:23], v[84:87]
    ds_read_b64_tr_b16 v[30:31], v51 offset:6144
    s_waitcnt lgkmcnt(8)
    v_mfma_f32_16x16x32_bf16 v[88:91], v[36:39], v[16:19], v[88:91]
    ds_read_b64_tr_b16 v[32:33], v48 offset:8192
    v_mfma_f32_16x16x32_bf16 v[92:95], v[36:39], v[20:23], v[92:95]
    ds_read_b64_tr_b16 v[34:35], v48 offset:10240
    s_waitcnt lgkmcnt(8)
    v_mfma_f32_16x16x32_bf16 v[96:99], v[40:43], v[16:19], v[96:99]
    ds_read_b64_tr_b16 v[36:37], v49 offset:8192
    v_mfma_f32_16x16x32_bf16 v[100:103], v[40:43], v[20:23], v[100:103]
    ds_read_b64_tr_b16 v[38:39], v49 offset:10240
    s_waitcnt lgkmcnt(8)
    v_mfma_f32_16x16x32_bf16 v[104:107], v[44:47], v[16:19], v[104:107]
    ds_read_b64_tr_b16 v[40:41], v50 offset:8192
    v_mfma_f32_16x16x32_bf16 v[108:111], v[44:47], v[20:23], v[108:111]
    ds_read_b64_tr_b16 v[42:43], v50 offset:10240
    s_waitcnt lgkmcnt(8)
    v_mfma_f32_16x16x32_bf16 v[112:115], v[24:27], v[16:19], v[112:115]
    ds_read_b64_tr_b16 v[44:45], v51 offset:8192
    v_mfma_f32_16x16x32_bf16 v[116:119], v[24:27], v[20:23], v[116:119]
    ds_read_b64_tr_b16 v[46:47], v51 offset:10240
    s_waitcnt lgkmcnt(8)
    v_mfma_f32_16x16x32_bf16 v[120:123], v[28:31], v[16:19], v[120:123]
    ds_read_b64_tr_b16 v[24:25], v48 offset:12288
    v_mfma_f32_16x16x32_bf16 v[124:127], v[28:31], v[20:23], v[124:127]
    ds_read_b64_tr_b16 v[26:27], v48 offset:14336
    s_waitcnt lgkmcnt(8)
    v_mfma_f32_16x16x32_bf16 v[128:131], v[32:35], v[16:19], v[128:131]
    ds_read_b64_tr_b16 v[28:29], v49 offset:12288
    v_mfma_f32_16x16x32_bf16 v[132:135], v[32:35], v[20:23], v[132:135]
    ds_read_b64_tr_b16 v[30:31], v49 offset:14336
    s_waitcnt lgkmcnt(8)
    v_mfma_f32_16x16x32_bf16 v[136:139], v[36:39], v[16:19], v[136:139]
    ds_read_b64_tr_b16 v[32:33], v50 offset:12288
    v_mfma_f32_16x16x32_bf16 v[140:143], v[36:39], v[20:23], v[140:143]
    ds_read_b64_tr_b16 v[34:35], v50 offset:14336
    s_waitcnt lgkmcnt(8)
    v_mfma_f32_16x16x32_bf16 v[144:147], v[40:43], v[16:19], v[144:147]
    ds_read_b64_tr_b16 v[36:37], v51 offset:12288
    v_mfma_f32_16x16x32_bf16 v[148:151], v[40:43], v[20:23], v[148:151]
    ds_read_b64_tr_b16 v[38:39], v51 offset:14336
    s_waitcnt lgkmcnt(8)
    v_mfma_f32_16x16x32_bf16 v[152:155], v[44:47], v[16:19], v[152:155]
    ds_read_b64_tr_b16 v[40:41], v48 offset:16384
    v_mfma_f32_16x16x32_bf16 v[156:159], v[44:47], v[20:23], v[156:159]
    ds_read_b64_tr_b16 v[42:43], v48 offset:18432
    s_waitcnt lgkmcnt(8)
    v_mfma_f32_16x16x32_bf16 v[160:163], v[24:27], v[16:19], v[160:163]
    ds_read_b64_tr_b16 v[44:45], v49 offset:16384
    v_mfma_f32_16x16x32_bf16 v[164:167], v[24:27], v[20:23], v[164:167]
    ds_read_b64_tr_b16 v[46:47], v49 offset:18432
    s_waitcnt lgkmcnt(8)
    v_mfma_f32_16x16x32_bf16 v[168:171], v[28:31], v[16:19], v[168:171]
    ds_read_b64_tr_b16 v[24:25], v50 offset:16384
    s_sub_u32 s40, s40, 1
    v_mfma_f32_16x16x32_bf16 v[172:175], v[28:31], v[20:23], v[172:175]
    ds_read_b64_tr_b16 v[26:27], v50 offset:18432
    s_waitcnt lgkmcnt(8)
    v_mfma_f32_16x16x32_bf16 v[176:179], v[32:35], v[16:19], v[176:179]
    ds_read_b64_tr_b16 v[28:29], v51 offset:16384
    s_cselect_b32 s41, s43, s42
    v_mfma_f32_16x16x32_bf16 v[180:183], v[32:35], v[20:23], v[180:183]
    ds_read_b64_tr_b16 v[30:31], v51 offset:18432
    s_waitcnt lgkmcnt(8)
    v_mfma_f32_16x16x32_bf16 v[184:187], v[36:39], v[16:19], v[184:187]
    ds_read_b64_tr_b16 v[32:33], v48 offset:20480
    s_cselect_b32 s40, 4, s40
    v_mfma_f32_16x16x32_bf16 v[188:191], v[36:39], v[20:23], v[188:191]
    ds_read_b64_tr_b16 v[34:35], v48 offset:22528
    s_waitcnt lgkmcnt(8)
    v_mfma_f32_16x16x32_bf16 v[192:195], v[40:43], v[16:19], v[192:195]
    ds_read_b64_tr_b16 v[36:37], v49 offset:20480
    v_add_u32 v48, s41, v48
    v_mfma_f32_16x16x32_bf16 v[196:199], v[40:43], v[20:23], v[196:199]
    ds_read_b64_tr_b16 v[38:39], v49 offset:22528
    s_waitcnt lgkmcnt(8)
    v_mfma_f32_16x16x32_bf16 v[200:203], v[44:47], v[16:19], v[200:203]
    ds_read_b64_tr_b16 v[40:41], v50 offset:20480
    v_add_u32 v49, s41, v49
    v_mfma_f32_16x16x32_bf16 v[204:207], v[44:47], v[20:23], v[204:207]
    ds_read_b64_tr_b16 v[42:43], v50 offset:22528
    s_waitcnt lgkmcnt(8)
    v_mfma_f32_16x16x32_bf16 v[208:211], v[24:27], v[16:19], v[208:211]
    ds_read_b64_tr_b16 v[44:45], v51 offset:20480
    v_add_u32 v50, s41, v50
    v_mfma_f32_16x16x32_bf16 v[212:215], v[24:27], v[20:23], v[212:215]
    ds_read_b64_tr_b16 v[46:47], v51 offset:22528
    s_waitcnt lgkmcnt(8)
    v_mfma_f32_16x16x32_bf16 v[216:219], v[28:31], v[16:19], v[216:219]
    s_barrier
    ds_read_b64_tr_b16 v[24:25], v48 offset:0
    ds_read_b128 v[8:11], v52 offset:0
    v_mfma_f32_16x16x32_bf16 v[220:223], v[28:31], v[20:23], v[220:223]
    ds_read_b64_tr_b16 v[26:27], v48 offset:2048
    s_waitcnt lgkmcnt(9)
    v_mfma_f32_16x16x32_bf16 v[224:227], v[32:35], v[16:19], v[224:227]
    ds_read_b64_tr_b16 v[28:29], v49 offset:0
    ds_read_b128 v[12:15], v52 offset:2048
    v_mfma_f32_16x16x32_bf16 v[228:231], v[32:35], v[20:23], v[228:231]
    ds_read_b64_tr_b16 v[30:31], v49 offset:2048
    s_waitcnt lgkmcnt(10)
    v_mfma_f32_16x16x32_bf16 v[232:235], v[36:39], v[16:19], v[232:235]
    ds_read_b64_tr_b16 v[32:33], v50 offset:0
    v_add_u32 v51, s41, v51
    v_mfma_f32_16x16x32_bf16 v[236:239], v[36:39], v[20:23], v[236:239]
    ds_read_b64_tr_b16 v[34:35], v50 offset:2048
    s_waitcnt lgkmcnt(10)
    v_mfma_f32_16x16x32_bf16 v[240:243], v[40:43], v[16:19], v[240:243]
    ds_read_b64_tr_b16 v[36:37], v51 offset:0
    v_mfma_f32_16x16x32_bf16 v[244:247], v[40:43], v[20:23], v[244:247]
    ds_read_b64_tr_b16 v[38:39], v51 offset:2048
    s_waitcnt lgkmcnt(10)
    v_mfma_f32_16x16x32_bf16 v[248:251], v[44:47], v[16:19], v[248:251]
    ds_read_b64_tr_b16 v[40:41], v48 offset:4096
    v_mfma_f32_16x16x32_bf16 v[252:255], v[44:47], v[20:23], v[252:255]
    ds_read_b64_tr_b16 v[42:43], v48 offset:6144
    s_waitcnt lgkmcnt(9)
    v_mfma_f32_16x16x32_bf16 v[64:67], v[24:27], v[8:11], v[64:67]
    ds_read_b64_tr_b16 v[44:45], v49 offset:4096
    s_waitcnt lgkmcnt(8)
    v_mfma_f32_16x16x32_bf16 v[68:71], v[24:27], v[12:15], v[68:71]
    ds_read_b64_tr_b16 v[46:47], v49 offset:6144
    s_waitcnt lgkmcnt(8)
    v_mfma_f32_16x16x32_bf16 v[72:75], v[28:31], v[8:11], v[72:75]
    ds_read_b64_tr_b16 v[24:25], v50 offset:4096
    v_xor_b32 v52, 64, v52
    v_mfma_f32_16x16x32_bf16 v[76:79], v[28:31], v[12:15], v[76:79]
    ds_read_b64_tr_b16 v[26:27], v50 offset:6144
    s_waitcnt lgkmcnt(8)
    v_mfma_f32_16x16x32_bf16 v[80:83], v[32:35], v[8:11], v[80:83]
    ds_read_b64_tr_b16 v[28:29], v51 offset:4096
    v_mfma_f32_16x16x32_bf16 v[84:87], v[32:35], v[12:15], v[84:87]
    ds_read_b64_tr_b16 v[30:31], v51 offset:6144
    s_waitcnt lgkmcnt(8)
    v_mfma_f32_16x16x32_bf16 v[88:91], v[36:39], v[8:11], v[88:91]
    ds_read_b64_tr_b16 v[32:33], v48 offset:8192
    v_mfma_f32_16x16x32_bf16 v[92:95], v[36:39], v[12:15], v[92:95]
    ds_read_b64_tr_b16 v[34:35], v48 offset:10240
    s_waitcnt lgkmcnt(8)
    v_mfma_f32_16x16x32_bf16 v[96:99], v[40:43], v[8:11], v[96:99]
    ds_read_b64_tr_b16 v[36:37], v49 offset:8192
    v_mfma_f32_16x16x32_bf16 v[100:103], v[40:43], v[12:15], v[100:103]
    ds_read_b64_tr_b16 v[38:39], v49 offset:10240
    s_waitcnt lgkmcnt(8)
    v_mfma_f32_16x16x32_bf16 v[104:107], v[44:47], v[8:11], v[104:107]
    ds_read_b64_tr_b16 v[40:41], v50 offset:8192
    v_mfma_f32_16x16x32_bf16 v[108:111], v[44:47], v[12:15], v[108:111]
    ds_read_b64_tr_b16 v[42:43], v50 offset:10240
    s_waitcnt lgkmcnt(8)
    v_mfma_f32_16x16x32_bf16 v[112:115], v[24:27], v[8:11], v[112:115]
    ds_read_b64_tr_b16 v[44:45], v51 offset:8192
    v_mfma_f32_16x16x32_bf16 v[116:119], v[24:27], v[12:15], v[116:119]
    ds_read_b64_tr_b16 v[46:47], v51 offset:10240
    s_waitcnt lgkmcnt(8)
    v_mfma_f32_16x16x32_bf16 v[120:123], v[28:31], v[8:11], v[120:123]
    ds_read_b64_tr_b16 v[24:25], v48 offset:12288
    v_mfma_f32_16x16x32_bf16 v[124:127], v[28:31], v[12:15], v[124:127]
    ds_read_b64_tr_b16 v[26:27], v48 offset:14336
    s_waitcnt lgkmcnt(8)
    v_mfma_f32_16x16x32_bf16 v[128:131], v[32:35], v[8:11], v[128:131]
    ds_read_b64_tr_b16 v[28:29], v49 offset:12288
    v_mfma_f32_16x16x32_bf16 v[132:135], v[32:35], v[12:15], v[132:135]
    ds_read_b64_tr_b16 v[30:31], v49 offset:14336
    s_waitcnt lgkmcnt(8)
    v_mfma_f32_16x16x32_bf16 v[136:139], v[36:39], v[8:11], v[136:139]
    ds_read_b64_tr_b16 v[32:33], v50 offset:12288
    v_mfma_f32_16x16x32_bf16 v[140:143], v[36:39], v[12:15], v[140:143]
    ds_read_b64_tr_b16 v[34:35], v50 offset:14336
    s_waitcnt lgkmcnt(8)
    v_mfma_f32_16x16x32_bf16 v[144:147], v[40:43], v[8:11], v[144:147]
    ds_read_b64_tr_b16 v[36:37], v51 offset:12288
    v_mfma_f32_16x16x32_bf16 v[148:151], v[40:43], v[12:15], v[148:151]
    ds_read_b64_tr_b16 v[38:39], v51 offset:14336
    s_waitcnt lgkmcnt(8)
    v_mfma_f32_16x16x32_bf16 v[152:155], v[44:47], v[8:11], v[152:155]
    ds_read_b64_tr_b16 v[40:41], v48 offset:16384
    v_mfma_f32_16x16x32_bf16 v[156:159], v[44:47], v[12:15], v[156:159]
    ds_read_b64_tr_b16 v[42:43], v48 offset:18432
    s_waitcnt lgkmcnt(8)
    v_mfma_f32_16x16x32_bf16 v[160:163], v[24:27], v[8:11], v[160:163]
    ds_read_b64_tr_b16 v[44:45], v49 offset:16384
    v_mfma_f32_16x16x32_bf16 v[164:167], v[24:27], v[12:15], v[164:167]
    ds_read_b64_tr_b16 v[46:47], v49 offset:18432
    s_waitcnt lgkmcnt(8)
    v_mfma_f32_16x16x32_bf16 v[168:171], v[28:31], v[8:11], v[168:171]
    ds_read_b64_tr_b16 v[24:25], v50 offset:16384
    s_sub_u32 s40, s40, 1
    v_mfma_f32_16x16x32_bf16 v[172:175], v[28:31], v[12:15], v[172:175]
    ds_read_b64_tr_b16 v[26:27], v50 offset:18432
    s_waitcnt lgkmcnt(8)
    v_mfma_f32_16x16x32_bf16 v[176:179], v[32:35], v[8:11], v[176:179]
    ds_read_b64_tr_b16 v[28:29], v51 offset:16384
    s_cselect_b32 s41, s43, s42
    v_mfma_f32_16x16x32_bf16 v[180:183], v[32:35], v[12:15], v[180:183]
    ds_read_b64_tr_b16 v[30:31], v51 offset:18432
    s_waitcnt lgkmcnt(8)
    v_mfma_f32_16x16x32_bf16 v[184:187], v[36:39], v[8:11], v[184:187]
    ds_read_b64_tr_b16 v[32:33], v48 offset:20480
    s_cselect_b32 s40, 4, s40
    v_mfma_f32_16x16x32_bf16 v[188:191], v[36:39], v[12:15], v[188:191]
    ds_read_b64_tr_b16 v[34:35], v48 offset:22528
    s_waitcnt lgkmcnt(8)
    v_mfma_f32_16x16x32_bf16 v[192:195], v[40:43], v[8:11], v[192:195]
    ds_read_b64_tr_b16 v[36:37], v49 offset:20480
    v_add_u32 v48, s41, v48
    v_mfma_f32_16x16x32_bf16 v[196:199], v[40:43], v[12:15], v[196:199]
    ds_read_b64_tr_b16 v[38:39], v49 offset:22528
    s_waitcnt lgkmcnt(8)
    v_mfma_f32_16x16x32_bf16 v[200:203], v[44:47], v[8:11], v[200:203]
    ds_read_b64_tr_b16 v[40:41], v50 offset:20480
    v_add_u32 v49, s41, v49
    v_mfma_f32_16x16x32_bf16 v[204:207], v[44:47], v[12:15], v[204:207]
    ds_read_b64_tr_b16 v[42:43], v50 offset:22528
    s_waitcnt lgkmcnt(8)
    v_mfma_f32_16x16x32_bf16 v[208:211], v[24:27], v[8:11], v[208:211]
    ds_read_b64_tr_b16 v[44:45], v51 offset:20480
    v_add_u32 v50, s41, v50
    v_mfma_f32_16x16x32_bf16 v[212:215], v[24:27], v[12:15], v[212:215]
    ds_read_b64_tr_b16 v[46:47], v51 offset:22528
    s_waitcnt lgkmcnt(8)
    v_mfma_f32_16x16x32_bf16 v[216:219], v[28:31], v[8:11], v[216:219]
    s_barrier
    ds_read_b64_tr_b16 v[24:25], v48 offset:0
    ds_read_b128 v[16:19], v52 offset:0
    v_mfma_f32_16x16x32_bf16 v[220:223], v[28:31], v[12:15], v[220:223]
    ds_read_b64_tr_b16 v[26:27], v48 offset:2048
    s_waitcnt lgkmcnt(9)
    v_mfma_f32_16x16x32_bf16 v[224:227], v[32:35], v[8:11], v[224:227]
    ds_read_b64_tr_b16 v[28:29], v49 offset:0
    ds_read_b128 v[20:23], v52 offset:2048
    v_mfma_f32_16x16x32_bf16 v[228:231], v[32:35], v[12:15], v[228:231]
    ds_read_b64_tr_b16 v[30:31], v49 offset:2048
    s_waitcnt lgkmcnt(10)
    v_mfma_f32_16x16x32_bf16 v[232:235], v[36:39], v[8:11], v[232:235]
    ds_read_b64_tr_b16 v[32:33], v50 offset:0
    v_add_u32 v51, s41, v51
    v_mfma_f32_16x16x32_bf16 v[236:239], v[36:39], v[12:15], v[236:239]
    ds_read_b64_tr_b16 v[34:35], v50 offset:2048
    s_waitcnt lgkmcnt(10)
    v_mfma_f32_16x16x32_bf16 v[240:243], v[40:43], v[8:11], v[240:243]
    ds_read_b64_tr_b16 v[36:37], v51 offset:0
    v_mfma_f32_16x16x32_bf16 v[244:247], v[40:43], v[12:15], v[244:247]
    ds_read_b64_tr_b16 v[38:39], v51 offset:2048
    s_waitcnt lgkmcnt(10)
    v_mfma_f32_16x16x32_bf16 v[248:251], v[44:47], v[8:11], v[248:251]
    ds_read_b64_tr_b16 v[40:41], v48 offset:4096
    s_sub_u32 s47, s47, 1
    v_mfma_f32_16x16x32_bf16 v[252:255], v[44:47], v[12:15], v[252:255]
    ds_read_b64_tr_b16 v[42:43], v48 offset:6144
    s_cbranch_scc0 L_g1
    s_waitcnt lgkmcnt(9)
    v_mfma_f32_16x16x32_bf16 v[64:67], v[24:27], v[16:19], v[64:67]
    ds_read_b64_tr_b16 v[44:45], v49 offset:4096
    ds_read_b128 v[60:63], v59 offset:0
    ds_read2_b32 v[10:11], v7 offset0:0 offset1:0
    s_waitcnt lgkmcnt(10)
    v_mfma_f32_16x16x32_bf16 v[68:71], v[24:27], v[20:23], v[68:71]
    ds_read_b64_tr_b16 v[46:47], v49 offset:6144
    ds_read2_b32 v[54:55], v7 offset0:16 offset1:16
    s_waitcnt lgkmcnt(11)
    v_mfma_f32_16x16x32_bf16 v[72:75], v[28:31], v[16:19], v[72:75]
    ds_read_b64_tr_b16 v[24:25], v50 offset:4096
    ds_read_b128 v[2:5], v59 offset:256
    v_mfma_f32_16x16x32_bf16 v[76:79], v[28:31], v[20:23], v[76:79]
    ds_read_b64_tr_b16 v[26:27], v50 offset:6144
    v_mov_b32 v12, 0
    s_waitcnt lgkmcnt(10)
    v_mfma_f32_16x16x32_bf16 v[80:83], v[32:35], v[16:19], v[80:83]
    ds_read_b64_tr_b16 v[28:29], v51 offset:4096
    v_mov_b32 v56, 0
    v_mfma_f32_16x16x32_bf16 v[84:87], v[32:35], v[20:23], v[84:87]
    ds_read_b64_tr_b16 v[30:31], v51 offset:6144
    v_mov_b32 v13, 0
    v_mfma_f32_16x16x32_bf16 v[88:91], v[36:39], v[16:19], v[88:91]
    ds_read_b64_tr_b16 v[32:33], v48 offset:8192
    v_mov_b32 v57, 0
    v_mfma_f32_16x16x32_bf16 v[92:95], v[36:39], v[20:23], v[92:95]
    ds_read_b64_tr_b16 v[34:35], v48 offset:10240
    s_waitcnt lgkmcnt(7)
    v_mfma_f32_16x16x32_bf16 v[64:67], v[60:63], v[10:13], v[64:67]
    v_mov_b32 v8, 0
    v_mov_b32 v9, 0
    v_mfma_f32_16x16x32_bf16 v[68:71], v[60:63], v[54:57], v[68:71]
    v_mov_b32 v52, 0
    v_mov_b32 v53, 0
    v_mfma_f32_16x16x32_bf16 v[96:99], v[40:43], v[16:19], v[96:99]
    ds_read_b64_tr_b16 v[36:37], v49 offset:8192
    v_mfma_f32_16x16x32_bf16 v[100:103], v[40:43], v[20:23], v[100:103]
    ds_read_b64_tr_b16 v[38:39], v49 offset:10240
    v_mfma_f32_16x16x32_bf16 v[72:75], v[60:63], v[8:11], v[72:75]
    v_mfma_f32_16x16x32_bf16 v[76:79], v[60:63], v[52:55], v[76:79]
    ds_read_b128 v[60:63], v59 offset:512
    v_cvt_pk_bf16_f32 v64, v64, v65
    v_mfma_f32_16x16x32_bf16 v[104:107], v[44:47], v[16:19], v[104:107]
    ds_read_b64_tr_b16 v[40:41], v50 offset:8192
    v_cvt_pk_bf16_f32 v65, v66, v67
    v_mfma_f32_16x16x32_bf16 v[108:111], v[44:47], v[20:23], v[108:111]
    ds_read_b64_tr_b16 v[42:43], v50 offset:10240
    s_waitcnt lgkmcnt(10)
    v_mfma_f32_16x16x32_bf16 v[80:83], v[2:5], v[10:13], v[80:83]
    v_pk_max_i16 v64, v64, 0
    v_pk_max_i16 v65, v65, 0
    v_mfma_f32_16x16x32_bf16 v[84:87], v[2:5], v[54:57], v[84:87]
    v_cvt_pk_bf16_f32 v68, v68, v69
    s_waitcnt lgkmcnt(7)
    v_mfma_f32_16x16x32_bf16 v[112:115], v[24:27], v[16:19], v[112:115]
    ds_read_b64_tr_b16 v[44:45], v51 offset:8192
    v_cvt_pk_bf16_f32 v69, v70, v71
    v_mfma_f32_16x16x32_bf16 v[116:119], v[24:27], v[20:23], v[116:119]
    ds_read_b64_tr_b16 v[46:47], v51 offset:10240
    v_pk_max_i16 v68, v68, 0
    v_mfma_f32_16x16x32_bf16 v[88:91], v[2:5], v[8:11], v[88:91]
    v_pk_max_i16 v69, v69, 0
    v_cvt_pk_bf16_f32 v66, v72, v73
    v_mfma_f32_16x16x32_bf16 v[92:95], v[2:5], v[52:55], v[92:95]
    ds_read_b128 v[2:5], v59 offset:768
L_pad0:
    s_cbranch_vccnz L_wret
    v_cvt_pk_bf16_f32 v67, v74, v75
    v_mfma_f32_16x16x32_bf16 v[120:123], v[28:31], v[16:19], v[120:123]
    ds_read_b64_tr_b16 v[24:25], v48 offset:12288
    v_pk_max_i16 v66, v66, 0
    v_mfma_f32_16x16x32_bf16 v[124:127], v[28:31], v[20:23], v[124:127]
    ds_read_b64_tr_b16 v[26:27], v48 offset:14336
    s_waitcnt lgkmcnt(7)
    v_mfma_f32_16x16x32_bf16 v[96:99], v[60:63], v[10:13], v[96:99]
    v_pk_max_i16 v67, v67, 0
    v_cvt_pk_bf16_f32 v70, v76, v77
    v_mfma_f32_16x16x32_bf16 v[100:103], v[60:63], v[54:57], v[100:103]
    v_cvt_pk_bf16_f32 v71, v78, v79
    v_pk_max_i16 v70, v70, 0
    v_mfma_f32_16x16x32_bf16 v[128:131], v[32:35], v[16:19], v[128:131]
    ds_read_b64_tr_b16 v[28:29], v49 offset:12288
    v_pk_max_i16 v71, v71, 0
    v_mfma_f32_16x16x32_bf16 v[132:135], v[32:35], v[20:23], v[132:135]
    ds_read_b64_tr_b16 v[30:31], v49 offset:14336
    v_cvt_pk_bf16_f32 v80, v80, v81
    v_mfma_f32_16x16x32_bf16 v[104:107], v[60:63], v[8:11], v[104:107]
    v_cvt_pk_bf16_f32 v81, v82, v83
    v_pk_max_i16 v80, v80, 0
    v_mfma_f32_16x16x32_bf16 v[108:111], v[60:63], v[52:55], v[108:111]
    ds_read_b128 v[60:63], v59 offset:1024
    v_pk_max_i16 v81, v81, 0
    v_mfma_f32_16x16x32_bf16 v[136:139], v[36:39], v[16:19], v[136:139]
    ds_read_b64_tr_b16 v[32:33], v50 offset:12288
    v_cvt_pk_bf16_f32 v84, v84, v85
    v_mfma_f32_16x16x32_bf16 v[140:143], v[36:39], v[20:23], v[140:143]
    ds_read_b64_tr_b16 v[34:35], v50 offset:14336
    s_waitcnt lgkmcnt(7)
    v_mfma_f32_16x16x32_bf16 v[112:115], v[2:5], v[10:13], v[112:115]
    v_cvt_pk_bf16_f32 v85, v86, v87
    v_pk_max_i16 v84, v84, 0
    v_mfma_f32_16x16x32_bf16 v[116:119], v[2:5], v[54:57], v[116:119]
    v_pk_max_i16 v85, v85, 0
    v_cvt_pk_bf16_f32 v82, v88, v89
    v_mfma_f32_16x16x32_bf16 v[144:147], v[40:43], v[16:19], v[144:147]
    ds_read_b64_tr_b16 v[36:37], v51 offset:12288
    v_cvt_pk_bf16_f32 v83, v90, v91
    v_mfma_f32_16x16x32_bf16 v[148:151], v[40:43], v[20:23], v[148:151]
    ds_read_b64_tr_b16 v[38:39], v51 offset:14336
    v_pk_max_i16 v82, v82, 0
    v_mfma_f32_16x16x32_bf16 v[120:123], v[2:5], v[8:11], v[120:123]
    v_pk_max_i16 v83, v83, 0
    v_cvt_pk_bf16_f32 v86, v92, v93
    v_mfma_f32_16x16x32_bf16 v[124:127], v[2:5], v[52:55], v[124:127]
    ds_read_b128 v[2:5], v59 offset:1280
    v_cvt_pk_bf16_f32 v87, v94, v95
    v_mfma_f32_16x16x32_bf16 v[152:155], v[44:47], v[16:19], v[152:155]
    ds_read_b64_tr_b16 v[40:41], v48 offset:16384
    v_pk_max_i16 v86, v86, 0
    v_mfma_f32_16x16x32_bf16 v[156:159], v[44:47], v[20:23], v[156:159]
    ds_read_b64_tr_b16 v[42:43], v48 offset:18432
    s_waitcnt lgkmcnt(7)
    v_mfma_f32_16x16x32_bf16 v[128:131], v[60:63], v[10:13], v[128:131]
    v_pk_max_i16 v87, v87, 0
    v_cvt_pk_bf16_f32 v96, v96, v97
    v_mfma_f32_16x16x32_bf16 v[132:135], v[60:63], v[54:57], v[132:135]
    v_cvt_pk_bf16_f32 v97, v98, v99
    v_pk_max_i16 v96, v96, 0
    v_mfma_f32_16x16x32_bf16 v[160:163], v[24:27], v[16:19], v[160:163]
    ds_read_b64_tr_b16 v[44:45], v49 offset:16384
    v_pk_max_i16 v97, v97, 0
    v_mfma_f32_16x16x32_bf16 v[164:167], v[24:27], v[20:23], v[164:167]
    ds_read_b64_tr_b16 v[46:47], v49 offset:18432
    v_cvt_pk_bf16_f32 v100, v100, v101
    v_mfma_f32_16x16x32_bf16 v[136:139], v[60:63], v[8:11], v[136:139]
    v_cvt_pk_bf16_f32 v101, v102, v103
    v_pk_max_i16 v100, v100, 0
    v_mfma_f32_16x16x32_bf16 v[140:143], v[60:63], v[52:55], v[140:143]
    ds_read_b128 v[60:63], v59 offset:1536
    v_pk_max_i16 v101, v101, 0
    v_mfma_f32_16x16x32_bf16 v[168:171], v[28:31], v[16:19], v[168:171]
    ds_read_b64_tr_b16 v[24:25], v50 offset:16384
    v_cvt_pk_bf16_f32 v98, v104, v105
    v_mfma_f32_16x16x32_bf16 v[172:175], v[28:31], v[20:23], v[172:175]
    ds_read_b64_tr_b16 v[26:27], v50 offset:18432
    s_waitcnt lgkmcnt(7)
    v_mfma_f32_16x16x32_bf16 v[144:147], v[2:5], v[10:13], v[144:147]
    v_cvt_pk_bf16_f32 v99, v106, v107
    v_pk_max_i16 v98, v98, 0
    v_mfma_f32_16x16x32_bf16 v[148:151], v[2:5], v[54:57], v[148:151]
    v_pk_max_i16 v99, v99, 0
    v_cvt_pk_bf16_f32 v102, v108, v109
    v_mfma_f32_16x16x32_bf16 v[176:179], v[32:35], v[16:19], v[176:179]
    ds_read_b64_tr_b16 v[28:29], v51 offset:16384
    v_cvt_pk_bf16_f32 v103, v110, v111
    v_mfma_f32_16x16x32_bf16 v[180:183], v[32:35], v[20:23], v[180:183]
    ds_read_b64_tr_b16 v[30:31], v51 offset:18432
    v_pk_max_i16 v102, v102, 0
    v_mfma_f32_16x16x32_bf16 v[152:155], v[2:5], v[8:11], v[152:155]
    v_pk_max_i16 v103, v103, 0
    v_cvt_pk_bf16_f32 v112, v112, v113
    v_mfma_f32_16x16x32_bf16 v[156:159], v[2:5], v[52:55], v[156:159]
    ds_read_b128 v[2:5], v59 offset:1792
    v_cvt_pk_bf16_f32 v113, v114, v115
    v_mfma_f32_16x16x32_bf16 v[184:187], v[36:39], v[16:19], v[184:187]
    ds_read_b64_tr_b16 v[32:33], v48 offset:20480
    v_pk_max_i16 v112, v112, 0
    v_mfma_f32_16x16x32_bf16 v[188:191], v[36:39], v[20:23], v[188:191]
    ds_read_b64_tr_b16 v[34:35], v48 offset:22528
    s_waitcnt lgkmcnt(7)
    v_mfma_f32_16x16x32_bf16 v[160:163], v[60:63], v[10:13], v[160:163]
    v_pk_max_i16 v113, v113, 0
    v_cvt_pk_bf16_f32 v116, v116, v117
    v_mfma_f32_16x16x32_bf16 v[164:167], v[60:63], v[54:57], v[164:167]
    v_cvt_pk_bf16_f32 v117, v118, v119
    v_pk_max_i16 v116, v116, 0
    v_mfma_f32_16x16x32_bf16 v[192:195], v[40:43], v[16:19], v[192:195]
    ds_read_b64_tr_b16 v[36:37], v49 offset:20480
    v_pk_max_i16 v117, v117, 0
    v_mfma_f32_16x16x32_bf16 v[196:199], v[40:43], v[20:23], v[196:199]
    ds_read_b64_tr_b16 v[38:39], v49 offset:22528
    v_cvt_pk_bf16_f32 v114, v120, v121
    v_mfma_f32_16x16x32_bf16 v[168:171], v[60:63], v[8:11], v[168:171]
    v_cvt_pk_bf16_f32 v115, v122, v123
    v_pk_max_i16 v114, v114, 0
    v_mfma_f32_16x16x32_bf16 v[172:175], v[60:63], v[52:55], v[172:175]
    ds_read_b128 v[60:63], v59 offset:2048
    v_pk_max_i16 v115, v115, 0
    v_mfma_f32_16x16x32_bf16 v[200:203], v[44:47], v[16:19], v[200:203]
    ds_read_b64_tr_b16 v[40:41], v50 offset:20480
    v_cvt_pk_bf16_f32 v118, v124, v125
    v_mfma_f32_16x16x32_bf16 v[204:207], v[44:47], v[20:23], v[204:207]
    ds_read_b64_tr_b16 v[42:43], v50 offset:22528
    s_waitcnt lgkmcnt(7)
    v_mfma_f32_16x16x32_bf16 v[176:179], v[2:5], v[10:13], v[176:179]
    v_cvt_pk_bf16_f32 v119, v126, v127
    v_pk_max_i16 v118, v118, 0
    v_mfma_f32_16x16x32_bf16 v[180:183], v[2:5], v[54:57], v[180:183]
    v_pk_max_i16 v119, v119, 0
    v_cvt_pk_bf16_f32 v128, v128, v129
    v_mfma_f32_16x16x32_bf16 v[208:211], v[24:27], v[16:19], v[208:211]
    ds_read_b64_tr_b16 v[44:45], v51 offset:20480
    v_cvt_pk_bf16_f32 v129, v130, v131
    v_mfma_f32_16x16x32_bf16 v[212:215], v[24:27], v[20:23], v[212:215]
    ds_read_b64_tr_b16 v[46:47], v51 offset:22528
    v_pk_max_i16 v128, v128, 0
    v_mfma_f32_16x16x32_bf16 v[184:187], v[2:5], v[8:11], v[184:187]
    v_pk_max_i16 v129, v129, 0
    v_cvt_pk_bf16_f32 v132, v132, v133
    v_mfma_f32_16x16x32_bf16 v[188:191], v[2:5], v[52:55], v[188:191]
    ds_read_b128 v[2:5], v59 offset:2304
    v_cvt_pk_bf16_f32 v133, v134, v135
    v_mfma_f32_16x16x32_bf16 v[216:219], v[28:31], v[16:19], v[216:219]
    s_barrier
    ds_read_b64_tr_b16 v[24:25], v48 offset:24576
    v_mfma_f32_16x16x32_bf16 v[220:223], v[28:31], v[20:23], v[220:223]
    ds_read_b64_tr_b16 v[26:27], v48 offset:26624
    s_waitcnt lgkmcnt(7)
    v_mfma_f32_16x16x32_bf16 v[192:195], v[60:63], v[10:13], v[192:195]
    v_pk_max_i16 v132, v132, 0
    v_pk_max_i16 v133, v133, 0
    v_mfma_f32_16x16x32_bf16 v[196:199], v[60:63], v[54:57], v[196:199]
    v_cvt_pk_bf16_f32 v130, v136, v137
    v_cvt_pk_bf16_f32 v131, v138, v139
    v_mfma_f32_16x16x32_bf16 v[224:227], v[32:35], v[16:19], v[224:227]
    ds_read_b64_tr_b16 v[28:29], v49 offset:24576
    v_pk_max_i16 v130, v130, 0
    v_mfma_f32_16x16x32_bf16 v[228:231], v[32:35], v[20:23], v[228:231]
    ds_read_b64_tr_b16 v[30:31], v49 offset:26624
    v_pk_max_i16 v131, v131, 0
    v_mfma_f32_16x16x32_bf16 v[200:203], v[60:63], v[8:11], v[200:203]
    v_cvt_pk_bf16_f32 v134, v140, v141
    v_cvt_pk_bf16_f32 v135, v142, v143
    v_mfma_f32_16x16x32_bf16 v[204:207], v[60:63], v[52:55], v[204:207]
    ds_read_b128 v[60:63], v59 offset:2560
    v_pk_max_i16 v134, v134, 0
    v_mfma_f32_16x16x32_bf16 v[232:235], v[36:39], v[16:19], v[232:235]
    ds_read_b64_tr_b16 v[32:33], v50 offset:24576
    v_pk_max_i16 v135, v135, 0
    v_mfma_f32_16x16x32_bf16 v[236:239], v[36:39], v[20:23], v[236:239]
    ds_read_b64_tr_b16 v[34:35], v50 offset:26624
    s_waitcnt lgkmcnt(7)
    v_mfma_f32_16x16x32_bf16 v[208:211], v[2:5], v[10:13], v[208:211]
    v_cvt_pk_bf16_f32 v144, v144, v145
    v_cvt_pk_bf16_f32 v145, v146, v147
    v_mfma_f32_16x16x32_bf16 v[212:215], v[2:5], v[54:57], v[212:215]
    v_pk_max_i16 v144, v144, 0
    v_pk_max_i16 v145, v145, 0
    v_mfma_f32_16x16x32_bf16 v[240:243], v[40:43], v[16:19], v[240:243]
    ds_read_b64_tr_b16 v[36:37], v51 offset:24576
    v_cvt_pk_bf16_f32 v148, v148, v149
    v_mfma_f32_16x16x32_bf16 v[244:247], v[40:43], v[20:23], v[244:247]
    ds_read_b64_tr_b16 v[38:39], v51 offset:26624
    v_cvt_pk_bf16_f32 v149, v150, v151
    v_mfma_f32_16x16x32_bf16 v[216:219], v[2:5], v[8:11], v[216:219]
    v_pk_max_i16 v148, v148, 0
    v_pk_max_i16 v149, v149, 0
    v_mfma_f32_16x16x32_bf16 v[220:223], v[2:5], v[52:55], v[220:223]
    ds_read_b128 v[2:5], v59 offset:2816
    v_cvt_pk_bf16_f32 v146, v152, v153
    v_mfma_f32_16x16x32_bf16 v[248:251], v[44:47], v[16:19], v[248:251]
    ds_read_b64_tr_b16 v[40:41], v48 offset:28672
    v_cvt_pk_bf16_f32 v147, v154, v155
    v_mfma_f32_16x16x32_bf16 v[252:255], v[44:47], v[20:23], v[252:255]
    ds_read_b64_tr_b16 v[42:43], v48 offset:30720
    s_waitcnt lgkmcnt(7)
    v_mfma_f32_16x16x32_bf16 v[224:227], v[60:63], v[10:13], v[224:227]
    v_pk_max_i16 v146, v146, 0
    v_pk_max_i16 v147, v147, 0
    v_mfma_f32_16x16x32_bf16 v[228:231], v[60:63], v[54:57], v[228:231]
    v_cvt_pk_bf16_f32 v150, v156, v157
    v_cvt_pk_bf16_f32 v151, v158, v159
    v_mfma_f32_16x16x32_bf16 v[232:235], v[60:63], v[8:11], v[232:235]
    v_pk_max_i16 v150, v150, 0
    v_pk_max_i16 v151, v151, 0
    v_mfma_f32_16x16x32_bf16 v[236:239], v[60:63], v[52:55], v[236:239]
    v_cvt_pk_bf16_f32 v160, v160, v161
    s_waitcnt lgkmcnt(2)
    v_mfma_f32_16x16x32_bf16 v[240:243], v[2:5], v[10:13], v[240:243]
    v_cvt_pk_bf16_f32 v161, v162, v163
    v_pk_max_i16 v160, v160, 0
    v_mfma_f32_16x16x32_bf16 v[244:247], v[2:5], v[54:57], v[244:247]
    v_pk_max_i16 v161, v161, 0
    v_cvt_pk_bf16_f32 v164, v164, v165
    v_mfma_f32_16x16x32_bf16 v[248:251], v[2:5], v[8:11], v[248:251]
    v_cvt_pk_bf16_f32 v165, v166, v167
    v_pk_max_i16 v164, v164, 0
    v_mfma_f32_16x16x32_bf16 v[252:255], v[2:5], v[52:55], v[252:255]
    v_pk_max_i16 v165, v165, 0
    v_cvt_pk_bf16_f32 v162, v168, v169
    v_mfma_f32_16x16x32_bf16 v[72:75], v[24:27], v[64:67], 0
    ds_read_b64_tr_b16 v[44:45], v49 offset:28672
    v_cvt_pk_bf16_f32 v163, v170, v171
    v_mfma_f32_16x16x32_bf16 v[76:79], v[24:27], v[68:71], 0
    ds_read_b64_tr_b16 v[46:47], v49 offset:30720
    v_pk_max_i16 v162, v162, 0
    v_mfma_f32_16x16x32_bf16 v[88:91], v[28:31], v[64:67], 0
    ds_read_b64_tr_b16 v[24:25], v50 offset:28672
    v_pk_max_i16 v163, v163, 0
    v_mfma_f32_16x16x32_bf16 v[92:95], v[28:31], v[68:71], 0
    ds_read_b64_tr_b16 v[26:27], v50 offset:30720
    v_cvt_pk_bf16_f32 v166, v172, v173
    v_mfma_f32_16x16x32_bf16 v[104:107], v[32:35], v[64:67], 0
    ds_read_b64_tr_b16 v[28:29], v51 offset:28672
    v_cvt_pk_bf16_f32 v167, v174, v175
    v_mfma_f32_16x16x32_bf16 v[108:111], v[32:35], v[68:71], 0
    ds_read_b64_tr_b16 v[30:31], v51 offset:30720
    v_pk_max_i16 v166, v166, 0
    v_mfma_f32_16x16x32_bf16 v[120:123], v[36:39], v[64:67], 0
    ds_read_b64_tr_b16 v[32:33], v48 offset:32768
    v_pk_max_i16 v167, v167, 0
    v_mfma_f32_16x16x32_bf16 v[124:127], v[36:39], v[68:71], 0
    ds_read_b64_tr_b16 v[34:35], v48 offset:34816
    s_waitcnt lgkmcnt(6)
    v_mfma_f32_16x16x32_bf16 v[72:75], v[40:43], v[80:83], v[72:75]
    ds_read_b64_tr_b16 v[36:37], v49 offset:32768
    v_cvt_pk_bf16_f32 v176, v176, v177
    v_mfma_f32_16x16x32_bf16 v[76:79], v[40:43], v[84:87], v[76:79]
    ds_read_b64_tr_b16 v[38:39], v49 offset:34816
    v_cvt_pk_bf16_f32 v177, v178, v179
    v_mfma_f32_16x16x32_bf16 v[88:91], v[44:47], v[80:83], v[88:91]
    ds_read_b64_tr_b16 v[40:41], v50 offset:32768
    v_pk_max_i16 v176, v176, 0
    v_mfma_f32_16x16x32_bf16 v[92:95], v[44:47], v[84:87], v[92:95]
    ds_read_b64_tr_b16 v[42:43], v50 offset:34816
    s_waitcnt lgkmcnt(6)
    v_mfma_f32_16x16x32_bf16 v[104:107], v[24:27], v[80:83], v[104:107]
    ds_read_b64_tr_b16 v[44:45], v51 offset:32768
    v_pk_max_i16 v177, v177, 0
    v_mfma_f32_16x16x32_bf16 v[108:111], v[24:27], v[84:87], v[108:111]
    ds_read_b64_tr_b16 v[46:47], v51 offset:34816
    v_cvt_pk_bf16_f32 v180, v180, v181
    v_mfma_f32_16x16x32_bf16 v[120:123], v[28:31], v[80:83], v[120:123]
    ds_read_b64_tr_b16 v[24:25], v48 offset:36864
    v_cvt_pk_bf16_f32 v181, v182, v183
    v_mfma_f32_16x16x32_bf16 v[124:127], v[28:31], v[84:87], v[124:127]
    ds_read_b64_tr_b16 v[26:27], v48 offset:38912
    s_waitcnt lgkmcnt(6)
    v_mfma_f32_16x16x32_bf16 v[72:75], v[32:35], v[96:99], v[72:75]
    ds_read_b64_tr_b16 v[28:29], v49 offset:36864
    v_pk_max_i16 v180, v180, 0
    v_mfma_f32_16x16x32_bf16 v[76:79], v[32:35], v[100:103], v[76:79]
    ds_read_b64_tr_b16 v[30:31], v49 offset:38912
    v_pk_max_i16 v181, v181, 0
    v_mfma_f32_16x16x32_bf16 v[88:91], v[36:39], v[96:99], v[88:91]
    ds_read_b64_tr_b16 v[32:33], v50 offset:36864
    v_cvt_pk_bf16_f32 v178, v184, v185
    v_mfma_f32_16x16x32_bf16 v[92:95], v[36:39], v[100:103], v[92:95]
    ds_read_b64_tr_b16 v[34:35], v50 offset:38912
    s_waitcnt lgkmcnt(6)
    v_mfma_f32_16x16x32_bf16 v[104:107], v[40:43], v[96:99], v[104:107]
    ds_read_b64_tr_b16 v[36:37], v51 offset:36864
    v_cvt_pk_bf16_f32 v179, v186, v187
    v_mfma_f32_16x16x32_bf16 v[108:111], v[40:43], v[100:103], v[108:111]
    ds_read_b64_tr_b16 v[38:39], v51 offset:38912
    v_pk_max_i16 v178, v178, 0
    v_mfma_f32_16x16x32_bf16 v[120:123], v[44:47], v[96:99], v[120:123]
    ds_read_b64_tr_b16 v[40:41], v48 offset:40960
    v_pk_max_i16 v179, v179, 0
    v_mfma_f32_16x16x32_bf16 v[124:127], v[44:47], v[100:103], v[124:127]
    ds_read_b64_tr_b16 v[42:43], v48 offset:43008
    s_waitcnt lgkmcnt(6)
    v_mfma_f32_16x16x32_bf16 v[72:75], v[24:27], v[112:115], v[72:75]
    ds_read_b64_tr_b16 v[44:45], v49 offset:40960
    v_cvt_pk_bf16_f32 v182, v188, v189
    v_mfma_f32_16x16x32_bf16 v[76:79], v[24:27], v[116:119], v[76:79]
    ds_read_b64_tr_b16 v[46:47], v49 offset:43008
    v_cvt_pk_bf16_f32 v183, v190, v191
    v_mfma_f32_16x16x32_bf16 v[88:91], v[28:31], v[112:115], v[88:91]
    ds_read_b64_tr_b16 v[24:25], v50 offset:40960
    v_pk_max_i16 v182, v182, 0
    v_mfma_f32_16x16x32_bf16 v[92:95], v[28:31], v[116:119], v[92:95]
    ds_read_b64_tr_b16 v[26:27], v50 offset:43008
    s_waitcnt lgkmcnt(6)
    v_mfma_f32_16x16x32_bf16 v[104:107], v[32:35], v[112:115], v[104:107]
    ds_read_b64_tr_b16 v[28:29], v51 offset:40960
    v_pk_max_i16 v183, v183, 0
    v_mfma_f32_16x16x32_bf16 v[108:111], v[32:35], v[116:119], v[108:111]
    ds_read_b64_tr_b16 v[30:31], v51 offset:43008
    v_cvt_pk_bf16_f32 v192, v192, v193
    v_mfma_f32_16x16x32_bf16 v[120:123], v[36:39], v[112:115], v[120:123]
    ds_read_b64_tr_b16 v[32:33], v48 offset:45056
    v_cvt_pk_bf16_f32 v193, v194, v195
    v_pk_max_i16 v192, v192, 0
    v_mfma_f32_16x16x32_bf16 v[124:127], v[36:39], v[116:119], v[124:127]
    ds_read_b64_tr_b16 v[34:35], v48 offset:47104
    s_waitcnt lgkmcnt(6)
    v_mfma_f32_16x16x32_bf16 v[72:75], v[40:43], v[128:131], v[72:75]
    ds_read_b64_tr_b16 v[36:37], v49 offset:45056
    v_add_u32 v48, 49152, v48
    v_pk_max_i16 v193, v193, 0
    v_mfma_f32_16x16x32_bf16 v[76:79], v[40:43], v[132:135], v[76:79]
    ds_read_b64_tr_b16 v[38:39], v49 offset:47104
    v_cvt_pk_bf16_f32 v196, v196, v197
    v_mfma_f32_16x16x32_bf16 v[88:91], v[44:47], v[128:131], v[88:91]
    ds_read_b64_tr_b16 v[40:41], v50 offset:45056
    v_add_u32 v49, 49152, v49
    v_cvt_pk_bf16_f32 v197, v198, v199
    v_mfma_f32_16x16x32_bf16 v[92:95], v[44:47], v[132:135], v[92:95]
    ds_read_b64_tr_b16 v[42:43], v50 offset:47104
    s_waitcnt lgkmcnt(6)
    v_mfma_f32_16x16x32_bf16 v[104:107], v[24:27], v[128:131], v[104:107]
    ds_read_b64_tr_b16 v[44:45], v51 offset:45056
    v_add_u32 v50, 49152, v50
    v_pk_max_i16 v196, v196, 0
    v_mfma_f32_16x16x32_bf16 v[108:111], v[24:27], v[132:135], v[108:111]
    ds_read_b64_tr_b16 v[46:47], v51 offset:47104
    v_pk_max_i16 v197, v197, 0
    v_mfma_f32_16x16x32_bf16 v[120:123], v[28:31], v[128:131], v[120:123]
    s_barrier
    ds_read_b64_tr_b16 v[24:25], v48 offset:0
    v_cvt_pk_bf16_f32 v194, v200, v201
    v_mfma_f32_16x16x32_bf16 v[124:127], v[28:31], v[132:135], v[124:127]
    ds_read_b64_tr_b16 v[26:27], v48 offset:2048
    s_waitcnt lgkmcnt(6)
    v_mfma_f32_16x16x32_bf16 v[72:75], v[32:35], v[144:147], v[72:75]
    ds_read_b64_tr_b16 v[28:29], v49 offset:0
    v_cvt_pk_bf16_f32 v195, v202, v203
    v_pk_max_i16 v194, v194, 0
    v_mfma_f32_16x16x32_bf16 v[76:79], v[32:35], v[148:151], v[76:79]
    ds_read_b64_tr_b16 v[30:31], v49 offset:2048
    v_pk_max_i16 v195, v195, 0
    v_mfma_f32_16x16x32_bf16 v[88:91], v[36:39], v[144:147], v[88:91]
    ds_read_b64_tr_b16 v[32:33], v50 offset:0
    v_add_u32 v51, 49152, v51
    v_cvt_pk_bf16_f32 v198, v204, v205
    v_mfma_f32_16x16x32_bf16 v[92:95], v[36:39], v[148:151], v[92:95]
    ds_read_b64_tr_b16 v[34:35], v50 offset:2048
    s_waitcnt lgkmcnt(6)
    v_mfma_f32_16x16x32_bf16 v[104:107], v[40:43], v[144:147], v[104:107]
    ds_read_b64_tr_b16 v[36:37], v51 offset:0
    v_cvt_pk_bf16_f32 v199, v206, v207
    v_pk_max_i16 v198, v198, 0
    v_mfma_f32_16x16x32_bf16 v[108:111], v[40:43], v[148:151], v[108:111]
    ds_read_b64_tr_b16 v[38:39], v51 offset:2048
    v_pk_max_i16 v199, v199, 0
    v_mfma_f32_16x16x32_bf16 v[120:123], v[44:47], v[144:147], v[120:123]
    ds_read_b64_tr_b16 v[40:41], v48 offset:4096
    v_cvt_pk_bf16_f32 v208, v208, v209
    v_cvt_pk_bf16_f32 v209, v210, v211
    v_mfma_f32_16x16x32_bf16 v[124:127], v[44:47], v[148:151], v[124:127]
    ds_read_b64_tr_b16 v[42:43], v48 offset:6144
    s_waitcnt lgkmcnt(6)
    v_mfma_f32_16x16x32_bf16 v[72:75], v[24:27], v[160:163], v[72:75]
    ds_read_b64_tr_b16 v[44:45], v49 offset:4096
    v_pk_max_i16 v208, v208, 0
    v_pk_max_i16 v209, v209, 0
    v_mfma_f32_16x16x32_bf16 v[76:79], v[24:27], v[164:167], v[76:79]
    ds_read_b64_tr_b16 v[46:47], v49 offset:6144
    v_cvt_pk_bf16_f32 v212, v212, v213
    v_mfma_f32_16x16x32_bf16 v[88:91], v[28:31], v[160:163], v[88:91]
    ds_read_b64_tr_b16 v[24:25], v50 offset:4096
    v_cvt_pk_bf16_f32 v213, v214, v215
    v_pk_max_i16 v212, v212, 0
    v_mfma_f32_16x16x32_bf16 v[92:95], v[28:31], v[164:167], v[92:95]
    ds_read_b64_tr_b16 v[26:27], v50 offset:6144
    s_waitcnt lgkmcnt(6)
    v_mfma_f32_16x16x32_bf16 v[104:107], v[32:35], v[160:163], v[104:107]
    ds_read_b64_tr_b16 v[28:29], v51 offset:4096
    v_pk_max_i16 v213, v213, 0
    v_cvt_pk_bf16_f32 v210, v216, v217
    v_mfma_f32_16x16x32_bf16 v[108:111], v[32:35], v[164:167], v[108:111]
    ds_read_b64_tr_b16 v[30:31], v51 offset:6144
    v_cvt_pk_bf16_f32 v211, v218, v219
    v_mfma_f32_16x16x32_bf16 v[120:123], v[36:39], v[160:163], v[120:123]
    ds_read_b64_tr_b16 v[32:33], v48 offset:8192
    v_pk_max_i16 v210, v210, 0
    v_pk_max_i16 v211, v211, 0
    v_mfma_f32_16x16x32_bf16 v[124:127], v[36:39], v[164:167], v[124:127]
    ds_read_b64_tr_b16 v[34:35], v48 offset:10240
    s_waitcnt lgkmcnt(6)
    v_mfma_f32_16x16x32_bf16 v[72:75], v[40:43], v[176:179], v[72:75]
    ds_read_b64_tr_b16 v[36:37], v49 offset:8192
    v_cvt_pk_bf16_f32 v214, v220, v221
    v_cvt_pk_bf16_f32 v215, v222, v223
    v_mfma_f32_16x16x32_bf16 v[76:79], v[40:43], v[180:183], v[76:79]
    ds_read_b64_tr_b16 v[38:39], v49 offset:10240
    v_pk_max_i16 v214, v214, 0
    v_mfma_f32_16x16x32_bf16 v[88:91], v[44:47], v[176:179], v[88:91]
    ds_read_b64_tr_b16 v[40:41], v50 offset:8192
    v_pk_max_i16 v215, v215, 0
    v_cvt_pk_bf16_f32 v224, v224, v225
    v_mfma_f32_16x16x32_bf16 v[92:95], v[44:47], v[180:183], v[92:95]
    ds_read_b64_tr_b16 v[42:43], v50 offset:10240
    s_waitcnt lgkmcnt(6)
    v_mfma_f32_16x16x32_bf16 v[104:107], v[24:27], v[176:179], v[104:107]
    ds_read_b64_tr_b16 v[44:45], v51 offset:8192
    v_cvt_pk_bf16_f32 v225, v226, v227
    v_pk_max_i16 v224, v224, 0
    v_mfma_f32_16x16x32_bf16 v[108:111], v[24:27], v[180:183], v[108:111]
    ds_read_b64_tr_b16 v[46:47], v51 offset:10240
    v_pk_max_i16 v225, v225, 0
    v_mfma_f32_16x16x32_bf16 v[120:123], v[28:31], v[176:179], v[120:123]
    ds_read_b64_tr_b16 v[24:25], v48 offset:12288
    v_cvt_pk_bf16_f32 v228, v228, v229
    v_cvt_pk_bf16_f32 v229, v230, v231
    v_mfma_f32_16x16x32_bf16 v[124:127], v[28:31], v[180:183], v[124:127]
    ds_read_b64_tr_b16 v[26:27], v48 offset:14336
    s_waitcnt lgkmcnt(6)
    v_mfma_f32_16x16x32_bf16 v[72:75], v[32:35], v[192:195], v[72:75]
    ds_read_b64_tr_b16 v[28:29], v49 offset:12288
    v_pk_max_i16 v228, v228, 0
    v_pk_max_i16 v229, v229, 0
    v_mfma_f32_16x16x32_bf16 v[76:79], v[32:35], v[196:199], v[76:79]
    ds_read_b64_tr_b16 v[30:31], v49 offset:14336
    v_cvt_pk_bf16_f32 v226, v232, v233
    v_mfma_f32_16x16x32_bf16 v[88:91], v[36:39], v[192:195], v[88:91]
    ds_read_b64_tr_b16 v[32:33], v50 offset:12288
    v_cvt_pk_bf16_f32 v227, v234, v235
    v_pk_max_i16 v226, v226, 0
    v_mfma_f32_16x16x32_bf16 v[92:95], v[36:39], v[196:199], v[92:95]
    ds_read_b64_tr_b16 v[34:35], v50 offset:14336
    s_waitcnt lgkmcnt(6)
    v_mfma_f32_16x16x32_bf16 v[104:107], v[40:43], v[192:195], v[104:107]
    ds_read_b64_tr_b16 v[36:37], v51 offset:12288
    v_pk_max_i16 v227, v227, 0
    v_cvt_pk_bf16_f32 v230, v236, v237
    v_mfma_f32_16x16x32_bf16 v[108:111], v[40:43], v[196:199], v[108:111]
    ds_read_b64_tr_b16 v[38:39], v51 offset:14336
    v_cvt_pk_bf16_f32 v231, v238, v239
    v_mfma_f32_16x16x32_bf16 v[120:123], v[44:47], v[192:195], v[120:123]
    ds_read_b64_tr_b16 v[40:41], v48 offset:16384
    v_pk_max_i16 v230, v230, 0
    v_pk_max_i16 v231, v231, 0
    v_mfma_f32_16x16x32_bf16 v[124:127], v[44:47], v[196:199], v[124:127]
    ds_read_b64_tr_b16 v[42:43], v48 offset:18432
    s_waitcnt lgkmcnt(6)
    v_mfma_f32_16x16x32_bf16 v[72:75], v[24:27], v[208:211], v[72:75]
    ds_read_b64_tr_b16 v[44:45], v49 offset:16384
    v_cvt_pk_bf16_f32 v240, v240, v241
    v_cvt_pk_bf16_f32 v241, v242, v243
    v_mfma_f32_16x16x32_bf16 v[76:79], v[24:27], v[212:215], v[76:79]
    ds_read_b64_tr_b16 v[46:47], v49 offset:18432
    v_pk_max_i16 v240, v240, 0
    v_mfma_f32_16x16x32_bf16 v[88:91], v[28:31], v[208:211], v[88:91]
    ds_read_b64_tr_b16 v[24:25], v50 offset:16384
    v_pk_max_i16 v241, v241, 0
    v_cvt_pk_bf16_f32 v244, v244, v245
    v_mfma_f32_16x16x32_bf16 v[92:95], v[28:31], v[212:215], v[92:95]
    ds_read_b64_tr_b16 v[26:27], v50 offset:18432
    s_waitcnt lgkmcnt(6)
    v_mfma_f32_16x16x32_bf16 v[104:107], v[32:35], v[208:211], v[104:107]
    ds_read_b64_tr_b16 v[28:29], v51 offset:16384
    v_cvt_pk_bf16_f32 v245, v246, v247
    v_pk_max_i16 v244, v244, 0
    v_mfma_f32_16x16x32_bf16 v[108:111], v[32:35], v[212:215], v[108:111]
    ds_read_b64_tr_b16 v[30:31], v51 offset:18432
    v_pk_max_i16 v245, v245, 0
    v_mfma_f32_16x16x32_bf16 v[120:123], v[36:39], v[208:211], v[120:123]
    ds_read_b64_tr_b16 v[32:33], v48 offset:20480
    v_cvt_pk_bf16_f32 v242, v248, v249
    v_cvt_pk_bf16_f32 v243, v250, v251
    v_mfma_f32_16x16x32_bf16 v[124:127], v[36:39], v[212:215], v[124:127]
    ds_read_b64_tr_b16 v[34:35], v48 offset:22528
    s_waitcnt lgkmcnt(6)
    v_mfma_f32_16x16x32_bf16 v[72:75], v[40:43], v[224:227], v[72:75]
    ds_read_b64_tr_b16 v[36:37], v49 offset:20480
    v_add_u32 v48, -98304, v48
    v_pk_max_i16 v242, v242, 0
    v_mfma_f32_16x16x32_bf16 v[76:79], v[40:43], v[228:231], v[76:79]
    ds_read_b64_tr_b16 v[38:39], v49 offset:22528
    v_pk_max_i16 v243, v243, 0
    v_mfma_f32_16x16x32_bf16 v[88:91], v[44:47], v[224:227], v[88:91]
    ds_read_b64_tr_b16 v[40:41], v50 offset:20480
    v_add_u32 v49, -98304, v49
    v_cvt_pk_bf16_f32 v246, v252, v253
    v_mfma_f32_16x16x32_bf16 v[92:95], v[44:47], v[228:231], v[92:95]
    ds_read_b64_tr_b16 v[42:43], v50 offset:22528
    s_waitcnt lgkmcnt(6)
    v_mfma_f32_16x16x32_bf16 v[104:107], v[24:27], v[224:227], v[104:107]
    ds_read_b64_tr_b16 v[44:45], v51 offset:20480
    v_add_u32 v50, -98304, v50
    v_cvt_pk_bf16_f32 v247, v254, v255
    v_mfma_f32_16x16x32_bf16 v[108:111], v[24:27], v[228:231], v[108:111]
    ds_read_b64_tr_b16 v[46:47], v51 offset:22528
    v_pk_max_i16 v246, v246, 0
    v_mfma_f32_16x16x32_bf16 v[120:123], v[28:31], v[224:227], v[120:123]
    s_barrier
    ds_read_b64_tr_b16 v[24:25], v48 offset:0
    v_pk_max_i16 v247, v247, 0
    v_mfma_f32_16x16x32_bf16 v[124:127], v[28:31], v[228:231], v[124:127]
    ds_read_b64_tr_b16 v[26:27], v48 offset:2048
    s_waitcnt lgkmcnt(6)
    v_mfma_f32_16x16x32_bf16 v[72:75], v[32:35], v[240:243], v[72:75]
    ds_read_b64_tr_b16 v[28:29], v49 offset:0
    v_mfma_f32_16x16x32_bf16 v[76:79], v[32:35], v[244:247], v[76:79]
    ds_read_b64_tr_b16 v[30:31], v49 offset:2048
    v_mfma_f32_16x16x32_bf16 v[88:91], v[36:39], v[240:243], v[88:91]
    ds_read_b64_tr_b16 v[32:33], v50 offset:0
    v_add_u32 v51, -98304, v51
    v_mfma_f32_16x16x32_bf16 v[92:95], v[36:39], v[244:247], v[92:95]
    ds_read_b64_tr_b16 v[34:35], v50 offset:2048
    s_waitcnt lgkmcnt(6)
    v_mfma_f32_16x16x32_bf16 v[104:107], v[40:43], v[240:243], v[104:107]
    ds_read_b64_tr_b16 v[36:37], v51 offset:0
    s_mov_b32 s47, 3
    v_mfma_f32_16x16x32_bf16 v[108:111], v[40:43], v[244:247], v[108:111]
L_pad1:
    s_cbranch_vccnz L_wret
    ds_read_b64_tr_b16 v[38:39], v51 offset:2048
    s_mov_b32 s40, 3
    v_mfma_f32_16x16x32_bf16 v[120:123], v[44:47], v[240:243], v[120:123]
    ds_read_b64_tr_b16 v[40:41], v48 offset:4096
    s_mov_b32 s49, s42
    v_mfma_f32_16x16x32_bf16 v[124:127], v[44:47], v[244:247], v[124:127]
    ds_read_b64_tr_b16 v[42:43], v48 offset:6144
L_g2:
    s_waitcnt lgkmcnt(6)
    v_mfma_f32_16x16x32_bf16 v[136:139], v[24:27], v[64:67], 0
    ds_read_b64_tr_b16 v[44:45], v49 offset:4096
    v_cvt_pk_bf16_f32 v200, v72, v73
    v_mfma_f32_16x16x32_bf16 v[140:143], v[24:27], v[68:71], 0
    ds_read_b64_tr_b16 v[46:47], v49 offset:6144
    v_mfma_f32_16x16x32_bf16 v[152:155], v[28:31], v[64:67], 0
    ds_read_b64_tr_b16 v[24:25], v50 offset:4096
    v_cvt_pk_bf16_f32 v201, v74, v75
    v_mfma_f32_16x16x32_bf16 v[156:159], v[28:31], v[68:71], 0
    ds_read_b64_tr_b16 v[26:27], v50 offset:6144
    s_waitcnt lgkmcnt(6)
    v_mfma_f32_16x16x32_bf16 v[168:171], v[32:35], v[64:67], 0
    ds_read_b64_tr_b16 v[28:29], v51 offset:4096
    v_cvt_pk_bf16_f32 v202, v88, v89
    v_mfma_f32_16x16x32_bf16 v[172:175], v[32:35], v[68:71], 0
    ds_read_b64_tr_b16 v[30:31], v51 offset:6144
    v_mfma_f32_16x16x32_bf16 v[184:187], v[36:39], v[64:67], 0
    ds_read_b64_tr_b16 v[32:33], v48 offset:8192
    v_cvt_pk_bf16_f32 v203, v90, v91
    v_mfma_f32_16x16x32_bf16 v[188:191], v[36:39], v[68:71], 0
    ds_read_b64_tr_b16 v[34:35], v48 offset:10240
    s_waitcnt lgkmcnt(6)
    v_mfma_f32_16x16x32_bf16 v[136:139], v[40:43], v[80:83], v[136:139]
    ds_read_b64_tr_b16 v[36:37], v49 offset:8192
    v_cvt_pk_bf16_f32 v216, v76, v77
    v_mfma_f32_16x16x32_bf16 v[140:143], v[40:43], v[84:87], v[140:143]
    ds_read_b64_tr_b16 v[38:39], v49 offset:10240
    v_mfma_f32_16x16x32_bf16 v[152:155], v[44:47], v[80:83], v[152:155]
    ds_read_b64_tr_b16 v[40:41], v50 offset:8192
    v_cvt_pk_bf16_f32 v217, v78, v79
    v_mfma_f32_16x16x32_bf16 v[156:159], v[44:47], v[84:87], v[156:159]
    ds_read_b64_tr_b16 v[42:43], v50 offset:10240
    s_waitcnt lgkmcnt(6)
    v_mfma_f32_16x16x32_bf16 v[168:171], v[24:27], v[80:83], v[168:171]
    ds_read_b64_tr_b16 v[44:45], v51 offset:8192
    v_cvt_pk_bf16_f32 v218, v92, v93
    v_mfma_f32_16x16x32_bf16 v[172:175], v[24:27], v[84:87], v[172:175]
    ds_read_b64_tr_b16 v[46:47], v51 offset:10240
    v_mfma_f32_16x16x32_bf16 v[184:187], v[28:31], v[80:83], v[184:187]
    ds_read_b64_tr_b16 v[24:25], v48 offset:12288
    v_cvt_pk_bf16_f32 v219, v94, v95
    v_mfma_f32_16x16x32_bf16 v[188:191], v[28:31], v[84:87], v[188:191]
    ds_read_b64_tr_b16 v[26:27], v48 offset:14336
    s_waitcnt vmcnt(0)
    s_waitcnt lgkmcnt(6)
    v_mfma_f32_16x16x32_bf16 v[136:139], v[32:35], v[96:99], v[136:139]
    ds_read_b64_tr_b16 v[28:29], v49 offset:12288
    buffer_atomic_add v1, v6, s[36:39], s48 offen sc1
    v_mfma_f32_16x16x32_bf16 v[140:143], v[32:35], v[100:103], v[140:143]
    ds_read_b64_tr_b16 v[30:31], v49 offset:14336
    v_mfma_f32_16x16x32_bf16 v[152:155], v[36:39], v[96:99], v[152:155]
    ds_read_b64_tr_b16 v[32:33], v50 offset:12288
    v_cvt_pk_bf16_f32 v204, v104, v105
    v_mfma_f32_16x16x32_bf16 v[156:159], v[36:39], v[100:103], v[156:159]
    ds_read_b64_tr_b16 v[34:35], v50 offset:14336
    s_waitcnt lgkmcnt(6)
    v_mfma_f32_16x16x32_bf16 v[168:171], v[40:43], v[96:99], v[168:171]
    ds_read_b64_tr_b16 v[36:37], v51 offset:12288
    buffer_store_dwordx4 v[200:203], v58, s[36:39], s44 offen offset:0 sc1
    v_mfma_f32_16x16x32_bf16 v[172:175], v[40:43], v[100:103], v[172:175]
    ds_read_b64_tr_b16 v[38:39], v51 offset:14336
    v_mfma_f32_16x16x32_bf16 v[184:187], v[44:47], v[96:99], v[184:187]
    ds_read_b64_tr_b16 v[40:41], v48 offset:16384
    v_cvt_pk_bf16_f32 v205, v106, v107
    v_mfma_f32_16x16x32_bf16 v[188:191], v[44:47], v[100:103], v[188:191]
    ds_read_b64_tr_b16 v[42:43], v48 offset:18432
    s_waitcnt lgkmcnt(6)
    v_mfma_f32_16x16x32_bf16 v[136:139], v[24:27], v[112:115], v[136:139]
    ds_read_b64_tr_b16 v[44:45], v49 offset:16384
    v_cvt_pk_bf16_f32 v206, v120, v121
    v_mfma_f32_16x16x32_bf16 v[140:143], v[24:27], v[116:119], v[140:143]
    ds_read_b64_tr_b16 v[46:47], v49 offset:18432
    v_mfma_f32_16x16x32_bf16 v[152:155], v[28:31], v[112:115], v[152:155]
    ds_read_b64_tr_b16 v[24:25], v50 offset:16384
    buffer_store_dwordx4 v[216:219], v58, s[36:39], s44 offen offset:2048 sc1
    v_mfma_f32_16x16x32_bf16 v[156:159], v[28:31], v[116:119], v[156:159]
    ds_read_b64_tr_b16 v[26:27], v50 offset:18432
    s_waitcnt lgkmcnt(6)
    v_mfma_f32_16x16x32_bf16 v[168:171], v[32:35], v[112:115], v[168:171]
    ds_read_b64_tr_b16 v[28:29], v51 offset:16384
    v_cvt_pk_bf16_f32 v207, v122, v123
    v_mfma_f32_16x16x32_bf16 v[172:175], v[32:35], v[116:119], v[172:175]
    ds_read_b64_tr_b16 v[30:31], v51 offset:18432
    v_mfma_f32_16x16x32_bf16 v[184:187], v[36:39], v[112:115], v[184:187]
    ds_read_b64_tr_b16 v[32:33], v48 offset:20480
    v_cvt_pk_bf16_f32 v220, v108, v109
    v_mfma_f32_16x16x32_bf16 v[188:191], v[36:39], v[116:119], v[188:191]
    ds_read_b64_tr_b16 v[34:35], v48 offset:22528
    v_cvt_pk_bf16_f32 v221, v110, v111
    s_waitcnt lgkmcnt(6)
    v_mfma_f32_16x16x32_bf16 v[136:139], v[40:43], v[128:131], v[136:139]
    ds_read_b64_tr_b16 v[36:37], v49 offset:20480
    buffer_store_dwordx4 v[204:207], v58, s[36:39], s44 offen offset:1024 sc1
    v_mfma_f32_16x16x32_bf16 v[140:143], v[40:43], v[132:135], v[140:143]
    ds_read_b64_tr_b16 v[38:39], v49 offset:22528
    v_add_u32 v48, s49, v48
    v_mfma_f32_16x16x32_bf16 v[152:155], v[44:47], v[128:131], v[152:155]
    ds_read_b64_tr_b16 v[40:41], v50 offset:20480
    v_cvt_pk_bf16_f32 v222, v124, v125
    v_mfma_f32_16x16x32_bf16 v[156:159], v[44:47], v[132:135], v[156:159]
    ds_read_b64_tr_b16 v[42:43], v50 offset:22528
    v_cvt_pk_bf16_f32 v223, v126, v127
    s_waitcnt lgkmcnt(6)
    v_mfma_f32_16x16x32_bf16 v[168:171], v[24:27], v[128:131], v[168:171]
    ds_read_b64_tr_b16 v[44:45], v51 offset:20480
    buffer_store_dwordx4 v[220:223], v58, s[36:39], s44 offen offset:3072 sc1
    v_mfma_f32_16x16x32_bf16 v[172:175], v[24:27], v[132:135], v[172:175]
    ds_read_b64_tr_b16 v[46:47], v51 offset:22528
    v_add_u32 v49, s49, v49
    v_mfma_f32_16x16x32_bf16 v[184:187], v[28:31], v[128:131], v[184:187]
    s_barrier
    ds_read_b64_tr_b16 v[24:25], v48 offset:0
    v_mfma_f32_16x16x32_bf16 v[188:191], v[28:31], v[132:135], v[188:191]
    ds_read_b64_tr_b16 v[26:27], v48 offset:2048
    s_waitcnt lgkmcnt(6)
    v_mfma_f32_16x16x32_bf16 v[136:139], v[32:35], v[144:147], v[136:139]
    ds_read_b64_tr_b16 v[28:29], v49 offset:0
    v_add_u32 v50, s49, v50
    v_mfma_f32_16x16x32_bf16 v[140:143], v[32:35], v[148:151], v[140:143]
    ds_read_b64_tr_b16 v[30:31], v49 offset:2048
    v_mfma_f32_16x16x32_bf16 v[152:155], v[36:39], v[144:147], v[152:155]
    ds_read_b64_tr_b16 v[32:33], v50 offset:0
    v_add_u32 v51, s49, v51
    v_mfma_f32_16x16x32_bf16 v[156:159], v[36:39], v[148:151], v[156:159]
    ds_read_b64_tr_b16 v[34:35], v50 offset:2048
    s_waitcnt lgkmcnt(6)
    v_mfma_f32_16x16x32_bf16 v[168:171], v[40:43], v[144:147], v[168:171]
    ds_read_b64_tr_b16 v[36:37], v51 offset:0
    v_mfma_f32_16x16x32_bf16 v[172:175], v[40:43], v[148:151], v[172:175]
    ds_read_b64_tr_b16 v[38:39], v51 offset:2048
    v_mfma_f32_16x16x32_bf16 v[184:187], v[44:47], v[144:147], v[184:187]
    ds_read_b64_tr_b16 v[40:41], v48 offset:4096
    v_mfma_f32_16x16x32_bf16 v[188:191], v[44:47], v[148:151], v[188:191]
    ds_read_b64_tr_b16 v[42:43], v48 offset:6144
    s_waitcnt lgkmcnt(8)
    v_mfma_f32_16x16x32_bf16 v[136:139], v[24:27], v[160:163], v[136:139]
    ds_read_b64_tr_b16 v[44:45], v49 offset:4096
    v_mfma_f32_16x16x32_bf16 v[140:143], v[24:27], v[164:167], v[140:143]
    ds_read_b64_tr_b16 v[46:47], v49 offset:6144
    s_waitcnt lgkmcnt(8)
    v_mfma_f32_16x16x32_bf16 v[152:155], v[28:31], v[160:163], v[152:155]
    ds_read_b64_tr_b16 v[24:25], v50 offset:4096
    v_mfma_f32_16x16x32_bf16 v[156:159], v[28:31], v[164:167], v[156:159]
    ds_read_b64_tr_b16 v[26:27], v50 offset:6144
    s_waitcnt lgkmcnt(8)
    v_mfma_f32_16x16x32_bf16 v[168:171], v[32:35], v[160:163], v[168:171]
    ds_read_b64_tr_b16 v[28:29], v51 offset:4096
    s_add_u32 s44, s44, 49152
    v_mfma_f32_16x16x32_bf16 v[172:175], v[32:35], v[164:167], v[172:175]
    ds_read_b64_tr_b16 v[30:31], v51 offset:6144
    s_waitcnt lgkmcnt(8)
    v_mfma_f32_16x16x32_bf16 v[184:187], v[36:39], v[160:163], v[184:187]
    ds_read_b64_tr_b16 v[32:33], v48 offset:8192
    s_cmp_eq_u32 s44, s46
    v_mfma_f32_16x16x32_bf16 v[188:191], v[36:39], v[164:167], v[188:191]
    ds_read_b64_tr_b16 v[34:35], v48 offset:10240
    s_waitcnt lgkmcnt(8)
    v_mfma_f32_16x16x32_bf16 v[136:139], v[40:43], v[176:179], v[136:139]
    ds_read_b64_tr_b16 v[36:37], v49 offset:8192
    s_cselect_b32 s44, s45, s44
    v_mfma_f32_16x16x32_bf16 v[140:143], v[40:43], v[180:183], v[140:143]
    ds_read_b64_tr_b16 v[38:39], v49 offset:10240
    s_waitcnt lgkmcnt(8)
    v_mfma_f32_16x16x32_bf16 v[152:155], v[44:47], v[176:179], v[152:155]
    ds_read_b64_tr_b16 v[40:41], v50 offset:8192
    v_mfma_f32_16x16x32_bf16 v[156:159], v[44:47], v[180:183], v[156:159]
    ds_read_b64_tr_b16 v[42:43], v50 offset:10240
    s_waitcnt lgkmcnt(8)
    v_mfma_f32_16x16x32_bf16 v[168:171], v[24:27], v[176:179], v[168:171]
    ds_read_b64_tr_b16 v[44:45], v51 offset:8192
    v_mfma_f32_16x16x32_bf16 v[172:175], v[24:27], v[180:183], v[172:175]
    ds_read_b64_tr_b16 v[46:47], v51 offset:10240
    s_waitcnt lgkmcnt(8)
    v_mfma_f32_16x16x32_bf16 v[184:187], v[28:31], v[176:179], v[184:187]
    ds_read_b64_tr_b16 v[24:25], v48 offset:12288
    v_mfma_f32_16x16x32_bf16 v[188:191], v[28:31], v[180:183], v[188:191]
    ds_read_b64_tr_b16 v[26:27], v48 offset:14336
    s_waitcnt lgkmcnt(8)
    v_mfma_f32_16x16x32_bf16 v[136:139], v[32:35], v[192:195], v[136:139]
    ds_read_b64_tr_b16 v[28:29], v49 offset:12288
    v_mfma_f32_16x16x32_bf16 v[140:143], v[32:35], v[196:199], v[140:143]
    ds_read_b64_tr_b16 v[30:31], v49 offset:14336
    s_waitcnt lgkmcnt(8)
    v_mfma_f32_16x16x32_bf16 v[152:155], v[36:39], v[192:195], v[152:155]
    ds_read_b64_tr_b16 v[32:33], v50 offset:12288
    v_mfma_f32_16x16x32_bf16 v[156:159], v[36:39], v[196:199], v[156:159]
    ds_read_b64_tr_b16 v[34:35], v50 offset:14336
    s_waitcnt lgkmcnt(8)
    v_mfma_f32_16x16x32_bf16 v[168:171], v[40:43], v[192:195], v[168:171]
    ds_read_b64_tr_b16 v[36:37], v51 offset:12288
    v_mfma_f32_16x16x32_bf16 v[172:175], v[40:43], v[196:199], v[172:175]
    ds_read_b64_tr_b16 v[38:39], v51 offset:14336
    s_waitcnt lgkmcnt(8)
    v_mfma_f32_16x16x32_bf16 v[184:187], v[44:47], v[192:195], v[184:187]
    ds_read_b64_tr_b16 v[40:41], v48 offset:16384
    s_add_u32 s48, s48, 8192
    v_mfma_f32_16x16x32_bf16 v[188:191], v[44:47], v[196:199], v[188:191]
    ds_read_b64_tr_b16 v[42:43], v48 offset:18432
    s_waitcnt lgkmcnt(8)
    v_mfma_f32_16x16x32_bf16 v[136:139], v[24:27], v[208:211], v[136:139]
    ds_read_b64_tr_b16 v[44:45], v49 offset:16384
    v_mfma_f32_16x16x32_bf16 v[140:143], v[24:27], v[212:215], v[140:143]
    ds_read_b64_tr_b16 v[46:47], v49 offset:18432
    s_waitcnt lgkmcnt(8)
    v_mfma_f32_16x16x32_bf16 v[152:155], v[28:31], v[208:211], v[152:155]
    ds_read_b64_tr_b16 v[24:25], v50 offset:16384
    s_sub_u32 s40, s40, 1
    v_mfma_f32_16x16x32_bf16 v[156:159], v[28:31], v[212:215], v[156:159]
    ds_read_b64_tr_b16 v[26:27], v50 offset:18432
    s_waitcnt lgkmcnt(8)
    v_mfma_f32_16x16x32_bf16 v[168:171], v[32:35], v[208:211], v[168:171]
    ds_read_b64_tr_b16 v[28:29], v51 offset:16384
    s_cselect_b32 s41, s43, s42
    v_mfma_f32_16x16x32_bf16 v[172:175], v[32:35], v[212:215], v[172:175]
    ds_read_b64_tr_b16 v[30:31], v51 offset:18432
    s_waitcnt lgkmcnt(8)
    v_mfma_f32_16x16x32_bf16 v[184:187], v[36:39], v[208:211], v[184:187]
    ds_read_b64_tr_b16 v[32:33], v48 offset:20480
    s_cselect_b32 s40, 4, s40
    v_mfma_f32_16x16x32_bf16 v[188:191], v[36:39], v[212:215], v[188:191]
    ds_read_b64_tr_b16 v[34:35], v48 offset:22528
    s_waitcnt lgkmcnt(8)
    v_mfma_f32_16x16x32_bf16 v[136:139], v[40:43], v[224:227], v[136:139]
    ds_read_b64_tr_b16 v[36:37], v49 offset:20480
    v_add_u32 v48, s41, v48
    v_mfma_f32_16x16x32_bf16 v[140:143], v[40:43], v[228:231], v[140:143]
    ds_read_b64_tr_b16 v[38:39], v49 offset:22528
    s_waitcnt lgkmcnt(8)
    v_mfma_f32_16x16x32_bf16 v[152:155], v[44:47], v[224:227], v[152:155]
    ds_read_b64_tr_b16 v[40:41], v50 offset:20480
    v_add_u32 v49, s41, v49
    v_mfma_f32_16x16x32_bf16 v[156:159], v[44:47], v[228:231], v[156:159]
    ds_read_b64_tr_b16 v[42:43], v50 offset:22528
    s_waitcnt lgkmcnt(8)
    v_mfma_f32_16x16x32_bf16 v[168:171], v[24:27], v[224:227], v[168:171]
    ds_read_b64_tr_b16 v[44:45], v51 offset:20480
    v_add_u32 v50, s41, v50
    v_mfma_f32_16x16x32_bf16 v[172:175], v[24:27], v[228:231], v[172:175]
    ds_read_b64_tr_b16 v[46:47], v51 offset:22528
    s_waitcnt lgkmcnt(8)
    v_mfma_f32_16x16x32_bf16 v[184:187], v[28:31], v[224:227], v[184:187]
    s_barrier
    ds_read_b64_tr_b16 v[24:25], v48 offset:0
    v_mfma_f32_16x16x32_bf16 v[188:191], v[28:31], v[228:231], v[188:191]
    ds_read_b64_tr_b16 v[26:27], v48 offset:2048
    s_waitcnt lgkmcnt(8)
    v_mfma_f32_16x16x32_bf16 v[136:139], v[32:35], v[240:243], v[136:139]
    ds_read_b64_tr_b16 v[28:29], v49 offset:0
    s_sub_u32 s40, s40, 1
    v_mfma_f32_16x16x32_bf16 v[140:143], v[32:35], v[244:247], v[140:143]
    ds_read_b64_tr_b16 v[30:31], v49 offset:2048
    s_waitcnt lgkmcnt(8)
    v_mfma_f32_16x16x32_bf16 v[152:155], v[36:39], v[240:243], v[152:155]
    ds_read_b64_tr_b16 v[32:33], v50 offset:0
    v_add_u32 v51, s41, v51
    v_mfma_f32_16x16x32_bf16 v[156:159], v[36:39], v[244:247], v[156:159]
    ds_read_b64_tr_b16 v[34:35], v50 offset:2048
    s_cselect_b32 s49, s43, s42
    s_waitcnt lgkmcnt(8)
    v_mfma_f32_16x16x32_bf16 v[168:171], v[40:43], v[240:243], v[168:171]
    ds_read_b64_tr_b16 v[36:37], v51 offset:0
    s_cselect_b32 s40, 4, s40
    v_mfma_f32_16x16x32_bf16 v[172:175], v[40:43], v[244:247], v[172:175]
    ds_read_b64_tr_b16 v[38:39], v51 offset:2048
    s_waitcnt lgkmcnt(8)
    v_mfma_f32_16x16x32_bf16 v[184:187], v[44:47], v[240:243], v[184:187]
    ds_read_b64_tr_b16 v[40:41], v48 offset:4096
    v_mfma_f32_16x16x32_bf16 v[188:191], v[44:47], v[244:247], v[188:191]
    ds_read_b64_tr_b16 v[42:43], v48 offset:6144
    s_waitcnt lgkmcnt(6)
    v_mfma_f32_16x16x32_bf16 v[72:75], v[24:27], v[64:67], 0
    ds_read_b64_tr_b16 v[44:45], v49 offset:4096
    v_cvt_pk_bf16_f32 v200, v136, v137
    v_mfma_f32_16x16x32_bf16 v[76:79], v[24:27], v[68:71], 0
    ds_read_b64_tr_b16 v[46:47], v49 offset:6144
    v_mfma_f32_16x16x32_bf16 v[88:91], v[28:31], v[64:67], 0
    ds_read_b64_tr_b16 v[24:25], v50 offset:4096
    v_cvt_pk_bf16_f32 v201, v138, v139
    v_mfma_f32_16x16x32_bf16 v[92:95], v[28:31], v[68:71], 0
    ds_read_b64_tr_b16 v[26:27], v50 offset:6144
    s_waitcnt lgkmcnt(6)
    v_mfma_f32_16x16x32_bf16 v[104:107], v[32:35], v[64:67], 0
    ds_read_b64_tr_b16 v[28:29], v51 offset:4096
    v_cvt_pk_bf16_f32 v202, v152, v153
    v_mfma_f32_16x16x32_bf16 v[108:111], v[32:35], v[68:71], 0
    ds_read_b64_tr_b16 v[30:31], v51 offset:6144
    v_mfma_f32_16x16x32_bf16 v[120:123], v[36:39], v[64:67], 0
    ds_read_b64_tr_b16 v[32:33], v48 offset:8192
    v_cvt_pk_bf16_f32 v203, v154, v155
    v_mfma_f32_16x16x32_bf16 v[124:127], v[36:39], v[68:71], 0
    ds_read_b64_tr_b16 v[34:35], v48 offset:10240
    s_waitcnt lgkmcnt(6)
    v_mfma_f32_16x16x32_bf16 v[72:75], v[40:43], v[80:83], v[72:75]
    ds_read_b64_tr_b16 v[36:37], v49 offset:8192
    v_cvt_pk_bf16_f32 v216, v140, v141
    v_mfma_f32_16x16x32_bf16 v[76:79], v[40:43], v[84:87], v[76:79]
    ds_read_b64_tr_b16 v[38:39], v49 offset:10240
    v_mfma_f32_16x16x32_bf16 v[88:91], v[44:47], v[80:83], v[88:91]
    ds_read_b64_tr_b16 v[40:41], v50 offset:8192
    v_cvt_pk_bf16_f32 v217, v142, v143
    v_mfma_f32_16x16x32_bf16 v[92:95], v[44:47], v[84:87], v[92:95]
    ds_read_b64_tr_b16 v[42:43], v50 offset:10240
    s_waitcnt lgkmcnt(6)
    v_mfma_f32_16x16x32_bf16 v[104:107], v[24:27], v[80:83], v[104:107]
    ds_read_b64_tr_b16 v[44:45], v51 offset:8192
    v_cvt_pk_bf16_f32 v218, v156, v157
    v_mfma_f32_16x16x32_bf16 v[108:111], v[24:27], v[84:87], v[108:111]
    ds_read_b64_tr_b16 v[46:47], v51 offset:10240
    v_mfma_f32_16x16x32_bf16 v[120:123], v[28:31], v[80:83], v[120:123]
    ds_read_b64_tr_b16 v[24:25], v48 offset:12288
    v_cvt_pk_bf16_f32 v219, v158, v159
    v_mfma_f32_16x16x32_bf16 v[124:127], v[28:31], v[84:87], v[124:127]
    ds_read_b64_tr_b16 v[26:27], v48 offset:14336
    s_waitcnt vmcnt(0)
    s_waitcnt lgkmcnt(6)
    v_mfma_f32_16x16x32_bf16 v[72:75], v[32:35], v[96:99], v[72:75]
    ds_read_b64_tr_b16 v[28:29], v49 offset:12288
    buffer_atomic_add v1, v6, s[36:39], s48 offen sc1
    v_mfma_f32_16x16x32_bf16 v[76:79], v[32:35], v[100:103], v[76:79]
    ds_read_b64_tr_b16 v[30:31], v49 offset:14336
    v_mfma_f32_16x16x32_bf16 v[88:91], v[36:39], v[96:99], v[88:91]
    ds_read_b64_tr_b16 v[32:33], v50 offset:12288
    v_cvt_pk_bf16_f32 v204, v168, v169
    v_mfma_f32_16x16x32_bf16 v[92:95], v[36:39], v[100:103], v[92:95]
    ds_read_b64_tr_b16 v[34:35], v50 offset:14336
    s_waitcnt lgkmcnt(6)
    v_mfma_f32_16x16x32_bf16 v[104:107], v[40:43], v[96:99], v[104:107]
    ds_read_b64_tr_b16 v[36:37], v51 offset:12288
    buffer_store_dwordx4 v[200:203], v58, s[36:39], s44 offen offset:0 sc1
    v_mfma_f32_16x16x32_bf16 v[108:111], v[40:43], v[100:103], v[108:111]
    ds_read_b64_tr_b16 v[38:39], v51 offset:14336
    v_mfma_f32_16x16x32_bf16 v[120:123], v[44:47], v[96:99], v[120:123]
    ds_read_b64_tr_b16 v[40:41], v48 offset:16384
    v_cvt_pk_bf16_f32 v205, v170, v171
    v_mfma_f32_16x16x32_bf16 v[124:127], v[44:47], v[100:103], v[124:127]
    ds_read_b64_tr_b16 v[42:43], v48 offset:18432
    s_waitcnt lgkmcnt(6)
    v_mfma_f32_16x16x32_bf16 v[72:75], v[24:27], v[112:115], v[72:75]
    ds_read_b64_tr_b16 v[44:45], v49 offset:16384
    v_cvt_pk_bf16_f32 v206, v184, v185
    v_mfma_f32_16x16x32_bf16 v[76:79], v[24:27], v[116:119], v[76:79]
    ds_read_b64_tr_b16 v[46:47], v49 offset:18432
    v_mfma_f32_16x16x32_bf16 v[88:91], v[28:31], v[112:115], v[88:91]
    ds_read_b64_tr_b16 v[24:25], v50 offset:16384
    buffer_store_dwordx4 v[216:219], v58, s[36:39], s44 offen offset:2048 sc1
    v_mfma_f32_16x16x32_bf16 v[92:95], v[28:31], v[116:119], v[92:95]
    ds_read_b64_tr_b16 v[26:27], v50 offset:18432
    s_waitcnt lgkmcnt(6)
    v_mfma_f32_16x16x32_bf16 v[104:107], v[32:35], v[112:115], v[104:107]
    ds_read_b64_tr_b16 v[28:29], v51 offset:16384
    v_cvt_pk_bf16_f32 v207, v186, v187
    v_mfma_f32_16x16x32_bf16 v[108:111], v[32:35], v[116:119], v[108:111]
    ds_read_b64_tr_b16 v[30:31], v51 offset:18432
    v_mfma_f32_16x16x32_bf16 v[120:123], v[36:39], v[112:115], v[120:123]
    ds_read_b64_tr_b16 v[32:33], v48 offset:20480
    v_cvt_pk_bf16_f32 v220, v172, v173
    v_mfma_f32_16x16x32_bf16 v[124:127], v[36:39], v[116:119], v[124:127]
    ds_read_b64_tr_b16 v[34:35], v48 offset:22528
    v_cvt_pk_bf16_f32 v221, v174, v175
    s_waitcnt lgkmcnt(6)
    v_mfma_f32_16x16x32_bf16 v[72:75], v[40:43], v[128:131], v[72:75]
    ds_read_b64_tr_b16 v[36:37], v49 offset:20480
    buffer_store_dwordx4 v[204:207], v58, s[36:39], s44 offen offset:1024 sc1
    v_mfma_f32_16x16x32_bf16 v[76:79], v[40:43], v[132:135], v[76:79]
    ds_read_b64_tr_b16 v[38:39], v49 offset:22528
    v_add_u32 v48, s49, v48
    v_mfma_f32_16x16x32_bf16 v[88:91], v[44:47], v[128:131], v[88:91]
    ds_read_b64_tr_b16 v[40:41], v50 offset:20480
    v_cvt_pk_bf16_f32 v222, v188, v189
    v_mfma_f32_16x16x32_bf16 v[92:95], v[44:47], v[132:135], v[92:95]
    ds_read_b64_tr_b16 v[42:43], v50 offset:22528
    v_cvt_pk_bf16_f32 v223, v190, v191
    s_waitcnt lgkmcnt(6)
    v_mfma_f32_16x16x32_bf16 v[104:107], v[24:27], v[128:131], v[104:107]
    ds_read_b64_tr_b16 v[44:45], v51 offset:20480
    buffer_store_dwordx4 v[220:223], v58, s[36:39], s44 offen offset:3072 sc1
    v_mfma_f32_16x16x32_bf16 v[108:111], v[24:27], v[132:135], v[108:111]
    ds_read_b64_tr_b16 v[46:47], v51 offset:22528
    v_add_u32 v49, s49, v49
    v_mfma_f32_16x16x32_bf16 v[120:123], v[28:31], v[128:131], v[120:123]
    s_barrier
    ds_read_b64_tr_b16 v[24:25], v48 offset:0
    v_mfma_f32_16x16x32_bf16 v[124:127], v[28:31], v[132:135], v[124:127]
    ds_read_b64_tr_b16 v[26:27], v48 offset:2048
    s_waitcnt lgkmcnt(6)
    v_mfma_f32_16x16x32_bf16 v[72:75], v[32:35], v[144:147], v[72:75]
    ds_read_b64_tr_b16 v[28:29], v49 offset:0
    v_add_u32 v50, s49, v50
    v_mfma_f32_16x16x32_bf16 v[76:79], v[32:35], v[148:151], v[76:79]
    ds_read_b64_tr_b16 v[30:31], v49 offset:2048
    v_mfma_f32_16x16x32_bf16 v[88:91], v[36:39], v[144:147], v[88:91]
    ds_read_b64_tr_b16 v[32:33], v50 offset:0
    v_add_u32 v51, s49, v51
    v_mfma_f32_16x16x32_bf16 v[92:95], v[36:39], v[148:151], v[92:95]
    ds_read_b64_tr_b16 v[34:35], v50 offset:2048
    s_waitcnt lgkmcnt(6)
    v_mfma_f32_16x16x32_bf16 v[104:107], v[40:43], v[144:147], v[104:107]
    ds_read_b64_tr_b16 v[36:37], v51 offset:0
    v_mfma_f32_16x16x32_bf16 v[108:111], v[40:43], v[148:151], v[108:111]
    ds_read_b64_tr_b16 v[38:39], v51 offset:2048
    v_mfma_f32_16x16x32_bf16 v[120:123], v[44:47], v[144:147], v[120:123]
    ds_read_b64_tr_b16 v[40:41], v48 offset:4096
    v_mfma_f32_16x16x32_bf16 v[124:127], v[44:47], v[148:151], v[124:127]
    ds_read_b64_tr_b16 v[42:43], v48 offset:6144
    s_waitcnt lgkmcnt(8)
    v_mfma_f32_16x16x32_bf16 v[72:75], v[24:27], v[160:163], v[72:75]
    ds_read_b64_tr_b16 v[44:45], v49 offset:4096
    v_mfma_f32_16x16x32_bf16 v[76:79], v[24:27], v[164:167], v[76:79]
    ds_read_b64_tr_b16 v[46:47], v49 offset:6144
    s_waitcnt lgkmcnt(8)
    v_mfma_f32_16x16x32_bf16 v[88:91], v[28:31], v[160:163], v[88:91]
    ds_read_b64_tr_b16 v[24:25], v50 offset:4096
    v_mfma_f32_16x16x32_bf16 v[92:95], v[28:31], v[164:167], v[92:95]
    ds_read_b64_tr_b16 v[26:27], v50 offset:6144
    s_waitcnt lgkmcnt(8)
    v_mfma_f32_16x16x32_bf16 v[104:107], v[32:35], v[160:163], v[104:107]
    ds_read_b64_tr_b16 v[28:29], v51 offset:4096
    s_add_u32 s44, s44, 49152
    v_mfma_f32_16x16x32_bf16 v[108:111], v[32:35], v[164:167], v[108:111]
    ds_read_b64_tr_b16 v[30:31], v51 offset:6144
    s_waitcnt lgkmcnt(8)
    v_mfma_f32_16x16x32_bf16 v[120:123], v[36:39], v[160:163], v[120:123]
    ds_read_b64_tr_b16 v[32:33], v48 offset:8192
    s_cmp_eq_u32 s44, s46
    v_mfma_f32_16x16x32_bf16 v[124:127], v[36:39], v[164:167], v[124:127]
    ds_read_b64_tr_b16 v[34:35], v48 offset:10240
    s_waitcnt lgkmcnt(8)
    v_mfma_f32_16x16x32_bf16 v[72:75], v[40:43], v[176:179], v[72:75]
    ds_read_b64_tr_b16 v[36:37], v49 offset:8192
    s_cselect_b32 s44, s45, s44
    v_mfma_f32_16x16x32_bf16 v[76:79], v[40:43], v[180:183], v[76:79]
    ds_read_b64_tr_b16 v[38:39], v49 offset:10240
    s_waitcnt lgkmcnt(8)
    v_mfma_f32_16x16x32_bf16 v[88:91], v[44:47], v[176:179], v[88:91]
    ds_read_b64_tr_b16 v[40:41], v50 offset:8192
    v_mfma_f32_16x16x32_bf16 v[92:95], v[44:47], v[180:183], v[92:95]
    ds_read_b64_tr_b16 v[42:43], v50 offset:10240
    s_waitcnt lgkmcnt(8)
    v_mfma_f32_16x16x32_bf16 v[104:107], v[24:27], v[176:179], v[104:107]
    ds_read_b64_tr_b16 v[44:45], v51 offset:8192
    v_mfma_f32_16x16x32_bf16 v[108:111], v[24:27], v[180:183], v[108:111]
    ds_read_b64_tr_b16 v[46:47], v51 offset:10240
    s_waitcnt lgkmcnt(8)
    v_mfma_f32_16x16x32_bf16 v[120:123], v[28:31], v[176:179], v[120:123]
    ds_read_b64_tr_b16 v[24:25], v48 offset:12288
    v_mfma_f32_16x16x32_bf16 v[124:127], v[28:31], v[180:183], v[124:127]
    ds_read_b64_tr_b16 v[26:27], v48 offset:14336
    s_waitcnt lgkmcnt(8)
    v_mfma_f32_16x16x32_bf16 v[72:75], v[32:35], v[192:195], v[72:75]
    ds_read_b64_tr_b16 v[28:29], v49 offset:12288
    v_mfma_f32_16x16x32_bf16 v[76:79], v[32:35], v[196:199], v[76:79]
    ds_read_b64_tr_b16 v[30:31], v49 offset:14336
    s_waitcnt lgkmcnt(8)
    v_mfma_f32_16x16x32_bf16 v[88:91], v[36:39], v[192:195], v[88:91]
    ds_read_b64_tr_b16 v[32:33], v50 offset:12288
    v_mfma_f32_16x16x32_bf16 v[92:95], v[36:39], v[196:199], v[92:95]
    ds_read_b64_tr_b16 v[34:35], v50 offset:14336
    s_waitcnt lgkmcnt(8)
    v_mfma_f32_16x16x32_bf16 v[104:107], v[40:43], v[192:195], v[104:107]
    ds_read_b64_tr_b16 v[36:37], v51 offset:12288
    v_mfma_f32_16x16x32_bf16 v[108:111], v[40:43], v[196:199], v[108:111]
    ds_read_b64_tr_b16 v[38:39], v51 offset:14336
    s_waitcnt lgkmcnt(8)
    v_mfma_f32_16x16x32_bf16 v[120:123], v[44:47], v[192:195], v[120:123]
    ds_read_b64_tr_b16 v[40:41], v48 offset:16384
    s_add_u32 s48, s48, 8192
    v_mfma_f32_16x16x32_bf16 v[124:127], v[44:47], v[196:199], v[124:127]
    ds_read_b64_tr_b16 v[42:43], v48 offset:18432
    s_waitcnt lgkmcnt(8)
    v_mfma_f32_16x16x32_bf16 v[72:75], v[24:27], v[208:211], v[72:75]
    ds_read_b64_tr_b16 v[44:45], v49 offset:16384
    v_mfma_f32_16x16x32_bf16 v[76:79], v[24:27], v[212:215], v[76:79]
    ds_read_b64_tr_b16 v[46:47], v49 offset:18432
    s_waitcnt lgkmcnt(8)
    v_mfma_f32_16x16x32_bf16 v[88:91], v[28:31], v[208:211], v[88:91]
    ds_read_b64_tr_b16 v[24:25], v50 offset:16384
    s_sub_u32 s40, s40, 1
    v_mfma_f32_16x16x32_bf16 v[92:95], v[28:31], v[212:215], v[92:95]
    ds_read_b64_tr_b16 v[26:27], v50 offset:18432
    s_waitcnt lgkmcnt(8)
    v_mfma_f32_16x16x32_bf16 v[104:107], v[32:35], v[208:211], v[104:107]
    ds_read_b64_tr_b16 v[28:29], v51 offset:16384
    s_cselect_b32 s41, s43, s42
    v_mfma_f32_16x16x32_bf16 v[108:111], v[32:35], v[212:215], v[108:111]
    ds_read_b64_tr_b16 v[30:31], v51 offset:18432
    s_waitcnt lgkmcnt(8)
    v_mfma_f32_16x16x32_bf16 v[120:123], v[36:39], v[208:211], v[120:123]
    ds_read_b64_tr_b16 v[32:33], v48 offset:20480
    s_cselect_b32 s40, 4, s40
    v_mfma_f32_16x16x32_bf16 v[124:127], v[36:39], v[212:215], v[124:127]
    ds_read_b64_tr_b16 v[34:35], v48 offset:22528
    s_waitcnt lgkmcnt(8)
    v_mfma_f32_16x16x32_bf16 v[72:75], v[40:43], v[224:227], v[72:75]
    ds_read_b64_tr_b16 v[36:37], v49 offset:20480
    v_add_u32 v48, s41, v48
    v_mfma_f32_16x16x32_bf16 v[76:79], v[40:43], v[228:231], v[76:79]
    ds_read_b64_tr_b16 v[38:39], v49 offset:22528
    s_waitcnt lgkmcnt(8)
    v_mfma_f32_16x16x32_bf16 v[88:91], v[44:47], v[224:227], v[88:91]
    ds_read_b64_tr_b16 v[40:41], v50 offset:20480
    v_add_u32 v49, s41, v49
    v_mfma_f32_16x16x32_bf16 v[92:95], v[44:47], v[228:231], v[92:95]
    ds_read_b64_tr_b16 v[42:43], v50 offset:22528
    s_waitcnt lgkmcnt(8)
    v_mfma_f32_16x16x32_bf16 v[104:107], v[24:27], v[224:227], v[104:107]
    ds_read_b64_tr_b16 v[44:45], v51 offset:20480
    v_add_u32 v50, s41, v50
    v_mfma_f32_16x16x32_bf16 v[108:111], v[24:27], v[228:231], v[108:111]
    ds_read_b64_tr_b16 v[46:47], v51 offset:22528
    s_waitcnt lgkmcnt(8)
    v_mfma_f32_16x16x32_bf16 v[120:123], v[28:31], v[224:227], v[120:123]
    s_barrier
    ds_read_b64_tr_b16 v[24:25], v48 offset:0
    v_mfma_f32_16x16x32_bf16 v[124:127], v[28:31], v[228:231], v[124:127]
    ds_read_b64_tr_b16 v[26:27], v48 offset:2048
    s_waitcnt lgkmcnt(8)
    v_mfma_f32_16x16x32_bf16 v[72:75], v[32:35], v[240:243], v[72:75]
    ds_read_b64_tr_b16 v[28:29], v49 offset:0
    s_sub_u32 s40, s40, 1
    v_mfma_f32_16x16x32_bf16 v[76:79], v[32:35], v[244:247], v[76:79]
    ds_read_b64_tr_b16 v[30:31], v49 offset:2048
    s_waitcnt lgkmcnt(8)
    v_mfma_f32_16x16x32_bf16 v[88:91], v[36:39], v[240:243], v[88:91]
    ds_read_b64_tr_b16 v[32:33], v50 offset:0
    v_add_u32 v51, s41, v51
    v_mfma_f32_16x16x32_bf16 v[92:95], v[36:39], v[244:247], v[92:95]
    ds_read_b64_tr_b16 v[34:35], v50 offset:2048
    s_cselect_b32 s49, s43, s42
    s_waitcnt lgkmcnt(8)
    v_mfma_f32_16x16x32_bf16 v[104:107], v[40:43], v[240:243], v[104:107]
    ds_read_b64_tr_b16 v[36:37], v51 offset:0
    s_cselect_b32 s40, 4, s40
    v_mfma_f32_16x16x32_bf16 v[108:111], v[40:43], v[244:247], v[108:111]
    ds_read_b64_tr_b16 v[38:39], v51 offset:2048
    s_waitcnt lgkmcnt(8)
    v_mfma_f32_16x16x32_bf16 v[120:123], v[44:47], v[240:243], v[120:123]
    ds_read_b64_tr_b16 v[40:41], v48 offset:4096
    s_sub_u32 s47, s47, 1
    v_mfma_f32_16x16x32_bf16 v[124:127], v[44:47], v[244:247], v[124:127]
    ds_read_b64_tr_b16 v[42:43], v48 offset:6144
    s_cbranch_scc0 L_g2
L_g2e:
    s_nop 1
    v_cvt_pk_bf16_f32 v200, v72, v73
    v_cvt_pk_bf16_f32 v201, v74, v75
    v_cvt_pk_bf16_f32 v202, v88, v89
    v_cvt_pk_bf16_f32 v203, v90, v91
    buffer_store_dwordx4 v[200:203], v58, s[36:39], s44 offen offset:0 sc1
    v_cvt_pk_bf16_f32 v216, v76, v77
    v_cvt_pk_bf16_f32 v217, v78, v79
    v_cvt_pk_bf16_f32 v218, v92, v93
    v_cvt_pk_bf16_f32 v219, v94, v95
    buffer_store_dwordx4 v[216:219], v58, s[36:39], s44 offen offset:2048 sc1
    v_cvt_pk_bf16_f32 v204, v104, v105
    v_cvt_pk_bf16_f32 v205, v106, v107
    v_cvt_pk_bf16_f32 v206, v120, v121
    v_cvt_pk_bf16_f32 v207, v122, v123
    buffer_store_dwordx4 v[204:207], v58, s[36:39], s44 offen offset:1024 sc1
    v_cvt_pk_bf16_f32 v220, v108, v109
    v_cvt_pk_bf16_f32 v221, v110, v111
    v_cvt_pk_bf16_f32 v222, v124, v125
    v_cvt_pk_bf16_f32 v223, v126, v127
L_pad2:
    s_cbranch_vccnz L_wret
    buffer_store_dwordx4 v[220:223], v58, s[36:39], s44 offen offset:3072 sc1
    v_mov_b32 v7, 1
    s_waitcnt vmcnt(4)
    buffer_atomic_add v7, v6, s[36:39], s48 offen sc1
    s_add_u32 s48, s48, 8192
    v_and_b32 v1, 15, v0
    v_lshrrev_b32 v2, 4, v0
    v_mul_u32_u24 v4, 1152, v1
    v_and_b32 v5, 1, v2
    v_lshl_add_u32 v4, v5, 5, v4
    v_lshrrev_b32 v5, 1, v2
    v_lshl_add_u32 v249, v5, 4, v4
    v_lshlrev_b32 v250, 3, v1
    v_lshlrev_b32 v4, 7, v0
    v_bfrev_b32 v5, 1
    s_mov_b64 s[64:65], 1
    s_mov_b64 s[66:67], 0xff
    v_cndmask_b32 v254, v5, v4, s[66:67]
    v_cndmask_b32 v253, v5, v4, s[64:65]
    v_lshlrev_b32 v248, 4, v0
    s_mov_b32 s40, s4
    s_mov_b32 s41, s5
    s_mov_b32 s42, 2359296
    s_mov_b32 s43, 0x20000
    buffer_load_dwordx4 v[232:235], v249, s[40:43], s10 offen
    buffer_load_dwordx2 v[236:237], v250, s[36:39], s11 offen sc1
    buffer_load_dword v3, v254, s[36:39], s14 offen sc1
    v_lshrrev_b32 v1, 2, v0
    v_and_b32 v2, 3, v0
    v_mul_u32_u24 v4, 1152, v1
    v_lshl_add_u32 v251, v2, 4, v4
    v_and_b32 v4, 1, v2
    v_lshl_add_u32 v1, v4, 5, v1
    v_lshrrev_b32 v4, 1, v2
    v_lshl_add_u32 v1, v4, 4, v1
    v_lshlrev_b32 v252, 2, v1
    s_mov_b32 s35, 0xffff0000
    s_mov_b32 s60, s22
    s_mov_b32 s61, s23
    s_mov_b32 s62, 2359296
    s_mov_b32 s63, 0x20000
    v_mov_b32 v2, 0
    buffer_atomic_add v2, v253, s[36:39], s12 offen sc0 sc1
    s_waitcnt vmcnt(5) lgkmcnt(0)
    buffer_atomic_add v7, v6, s[36:39], s48 offen sc1
    s_waitcnt vmcnt(1)
L_rlc:
    v_cmp_le_u32 vcc, 1, v3
    v_readfirstlane_b32 s3, v2
    s_nop 0
    s_cmp_ge_u32 s3, 12
    s_cselect_b32 s6, 1, 0
    s_cmp_eq_u32 vcc_lo, 0xff
    s_cbranch_scc0 L_rl1
    s_cmp_eq_u32 s6, 0
    s_cbranch_scc1 L_rly
    buffer_load_dwordx4 v[8:11], v248, s[36:39], s9 offen offset:0 sc1
    buffer_load_dwordx4 v[12:15], v248, s[36:39], s9 offen offset:1024 sc1
    s_mov_b32 s64, s8
    buffer_load_dwordx4 v[80:83], v248, s[36:39], s64 offen sc1
    s_add_u32 s64, s64, 4096
    buffer_load_dwordx4 v[84:87], v248, s[36:39], s64 offen sc1
    s_add_u32 s64, s64, 4096
    buffer_load_dwordx4 v[88:91], v248, s[36:39], s64 offen sc1
    s_add_u32 s64, s64, 4096
    buffer_load_dwordx4 v[92:95], v248, s[36:39], s64 offen sc1
    s_add_u32 s64, s64, 4096
    buffer_load_dwordx4 v[96:99], v248, s[36:39], s64 offen sc1
    s_add_u32 s64, s64, 4096
    buffer_load_dwordx4 v[100:103], v248, s[36:39], s64 offen sc1
    s_add_u32 s64, s64, 4096
    buffer_load_dwordx4 v[104:107], v248, s[36:39], s64 offen sc1
    s_add_u32 s64, s64, 4096
    buffer_load_dwordx4 v[108:111], v248, s[36:39], s64 offen sc1
    s_add_u32 s64, s64, 4096
    buffer_load_dwordx4 v[112:115], v248, s[36:39], s64 offen sc1
    s_add_u32 s64, s64, 4096
    buffer_load_dwordx4 v[116:119], v248, s[36:39], s64 offen sc1
    s_add_u32 s64, s64, 4096
    buffer_load_dwordx4 v[120:123], v248, s[36:39], s64 offen sc1
    s_add_u32 s64, s64, 4096
    buffer_load_dwordx4 v[124:127], v248, s[36:39], s64 offen sc1
    s_waitcnt vmcnt(12)
    s_branch L_rlb
L_rly:
    buffer_load_dwordx4 v[8:11], v248, s[36:39], s9 offen offset:0 sc1
    buffer_load_dwordx4 v[12:15], v248, s[36:39], s9 offen offset:1024 sc1
    s_cmp_lg_u32 s6, 0
    s_cbranch_scc1 L_rlw
    v_mov_b32 v40, 0
    buffer_atomic_add v40, v253, s[36:39], s12 offen sc0 sc1
    s_waitcnt vmcnt(1)
L_rlb:
    v_permlane16_swap_b32 v232, v234
    v_permlane16_swap_b32 v233, v235
    v_perm_b32 v8, v8, v8, s13
    v_perm_b32 v9, v9, v9, s13
    v_perm_b32 v10, v10, v10, s13
    v_perm_b32 v11, v11, v11, s13
    v_perm_b32 v12, v12, v12, s13
    v_perm_b32 v13, v13, v13, s13
    v_perm_b32 v14, v14, v14, s13
    v_perm_b32 v15, v15, v15, s13
    v_lshlrev_b32 v24, 16, v232
    v_and_b32 v25, s35, v232
    v_sub_f32 v26, v24, v236
    v_sub_f32 v27, v25, v236
    v_mul_f32 v26, v26, v237
    v_mul_f32 v27, v27, v237
    v_fma_f32 v8, v26, v8, v24
    v_fma_f32 v9, v27, v9, v25
    v_lshlrev_b32 v24, 16, v233
    v_and_b32 v25, s35, v233
    v_sub_f32 v26, v24, v236
    v_sub_f32 v27, v25, v236
    v_mul_f32 v26, v26, v237
    v_mul_f32 v27, v27, v237
    v_fma_f32 v10, v26, v10, v24
    v_fma_f32 v11, v27, v11, v25
    v_lshlrev_b32 v24, 16, v234
    v_and_b32 v25, s35, v234
    v_sub_f32 v26, v24, v236
    v_sub_f32 v27, v25, v236
    v_mul_f32 v26, v26, v237
    v_mul_f32 v27, v27, v237
    v_fma_f32 v12, v26, v12, v24
    v_fma_f32 v13, v27, v13, v25
    v_lshlrev_b32 v24, 16, v235
    v_and_b32 v25, s35, v235
    v_sub_f32 v26, v24, v236
    v_sub_f32 v27, v25, v236
    v_mul_f32 v26, v26, v237
    v_mul_f32 v27, v27, v237
    v_fma_f32 v14, v26, v14, v24
    v_fma_f32 v15, v27, v15, v25
    s_cmp_lg_u32 s6, 0
    s_cbranch_scc1 L_rl4
    v_mov_b32 v41, 0
    buffer_atomic_add v41, v253, s[36:39], s12 offen sc0 sc1
L_rlp:
    s_waitcnt vmcnt(1)
    v_readfirstlane_b32 s3, v40
    s_nop 0
    s_cmp_ge_u32 s3, 12
    s_cbranch_scc1 L_rlq
    v_mov_b32 v40, 0
    buffer_atomic_add v40, v253, s[36:39], s12 offen sc0 sc1
    s_waitcnt vmcnt(1)
    v_readfirstlane_b32 s3, v41
    s_nop 0
    s_cmp_ge_u32 s3, 12
    s_cbranch_scc1 L_rlq
    v_mov_b32 v41, 0
    buffer_atomic_add v41, v253, s[36:39], s12 offen sc0 sc1
    s_sub_u32 s74, s74, 1
    s_cbranch_scc0 L_rlp
    s_mov_b32 s74, 0
L_rlq:
    s_mov_b32 s64, s8
    buffer_load_dwordx4 v[80:83], v248, s[36:39], s64 offen sc1
    s_add_u32 s64, s64, 4096
    buffer_load_dwordx4 v[84:87], v248, s[36:39], s64 offen sc1
    s_add_u32 s64, s64, 4096
    buffer_load_dwordx4 v[88:91], v248, s[36:39], s64 offen sc1
    s_add_u32 s64, s64, 4096
    buffer_load_dwordx4 v[92:95], v248, s[36:39], s64 offen sc1
    s_add_u32 s64, s64, 4096
    buffer_load_dwordx4 v[96:99], v248, s[36:39], s64 offen sc1
    s_add_u32 s64, s64, 4096
    buffer_load_dwordx4 v[100:103], v248, s[36:39], s64 offen sc1
    s_add_u32 s64, s64, 4096
    buffer_load_dwordx4 v[104:107], v248, s[36:39], s64 offen sc1
    s_add_u32 s64, s64, 4096
    buffer_load_dwordx4 v[108:111], v248, s[36:39], s64 offen sc1
    s_add_u32 s64, s64, 4096
    buffer_load_dwordx4 v[112:115], v248, s[36:39], s64 offen sc1
    s_add_u32 s64, s64, 4096
    buffer_load_dwordx4 v[116:119], v248, s[36:39], s64 offen sc1
    s_add_u32 s64, s64, 4096
    buffer_load_dwordx4 v[120:123], v248, s[36:39], s64 offen sc1
    s_add_u32 s64, s64, 4096
    buffer_load_dwordx4 v[124:127], v248, s[36:39], s64 offen sc1
L_rl4:
    s_waitcnt vmcnt(11)
    v_lshlrev_b32 v16, 16, v80
    v_and_b32 v17, s35, v80
    v_lshlrev_b32 v18, 16, v81
    v_and_b32 v19, s35, v81
    v_lshlrev_b32 v20, 16, v82
    v_and_b32 v21, s35, v82
    v_lshlrev_b32 v22, 16, v83
    v_and_b32 v23, s35, v83
    s_waitcnt vmcnt(10)
    v_lshlrev_b32 v24, 16, v84
    v_and_b32 v25, s35, v84
    v_lshlrev_b32 v26, 16, v85
    v_and_b32 v27, s35, v85
    v_lshlrev_b32 v28, 16, v86
    v_and_b32 v29, s35, v86
    v_lshlrev_b32 v30, 16, v87
    v_and_b32 v31, s35, v87
    v_pk_add_f32 v[16:17], v[16:17], v[24:25]
    v_pk_add_f32 v[18:19], v[18:19], v[26:27]
    v_pk_add_f32 v[20:21], v[20:21], v[28:29]
    v_pk_add_f32 v[22:23], v[22:23], v[30:31]
    s_waitcnt vmcnt(9)
    v_lshlrev_b32 v24, 16, v88
    v_and_b32 v25, s35, v88
    v_lshlrev_b32 v26, 16, v89
    v_and_b32 v27, s35, v89
    v_lshlrev_b32 v28, 16, v90
    v_and_b32 v29, s35, v90
    v_lshlrev_b32 v30, 16, v91
    v_and_b32 v31, s35, v91
    v_pk_add_f32 v[16:17], v[16:17], v[24:25]
    v_pk_add_f32 v[18:19], v[18:19], v[26:27]
    v_pk_add_f32 v[20:21], v[20:21], v[28:29]
    v_pk_add_f32 v[22:23], v[22:23], v[30:31]
    s_waitcnt vmcnt(8)
    v_lshlrev_b32 v24, 16, v92
    v_and_b32 v25, s35, v92
    v_lshlrev_b32 v26, 16, v93
    v_and_b32 v27, s35, v93
    v_lshlrev_b32 v28, 16, v94
    v_and_b32 v29, s35, v94
    v_lshlrev_b32 v30, 16, v95
    v_and_b32 v31, s35, v95
    v_pk_add_f32 v[16:17], v[16:17], v[24:25]
    v_pk_add_f32 v[18:19], v[18:19], v[26:27]
    v_pk_add_f32 v[20:21], v[20:21], v[28:29]
    v_pk_add_f32 v[22:23], v[22:23], v[30:31]
    s_waitcnt vmcnt(7)
    v_lshlrev_b32 v24, 16, v96
    v_and_b32 v25, s35, v96
    v_lshlrev_b32 v26, 16, v97
    v_and_b32 v27, s35, v97
    v_lshlrev_b32 v28, 16, v98
    v_and_b32 v29, s35, v98
    v_lshlrev_b32 v30, 16, v99
    v_and_b32 v31, s35, v99
    v_pk_add_f32 v[16:17], v[16:17], v[24:25]
    v_pk_add_f32 v[18:19], v[18:19], v[26:27]
    v_pk_add_f32 v[20:21], v[20:21], v[28:29]
    v_pk_add_f32 v[22:23], v[22:23], v[30:31]
    s_waitcnt vmcnt(6)
    v_lshlrev_b32 v24, 16, v100
    v_and_b32 v25, s35, v100
    v_lshlrev_b32 v26, 16, v101
    v_and_b32 v27, s35, v101
    v_lshlrev_b32 v28, 16, v102
    v_and_b32 v29, s35, v102
    v_lshlrev_b32 v30, 16, v103
    v_and_b32 v31, s35, v103
    v_pk_add_f32 v[16:17], v[16:17], v[24:25]
    v_pk_add_f32 v[18:19], v[18:19], v[26:27]
    v_pk_add_f32 v[20:21], v[20:21], v[28:29]
    v_pk_add_f32 v[22:23], v[22:23], v[30:31]
    s_waitcnt vmcnt(5)
    v_lshlrev_b32 v24, 16, v104
    v_and_b32 v25, s35, v104
    v_lshlrev_b32 v26, 16, v105
    v_and_b32 v27, s35, v105
    v_lshlrev_b32 v28, 16, v106
    v_and_b32 v29, s35, v106
    v_lshlrev_b32 v30, 16, v107
    v_and_b32 v31, s35, v107
    v_pk_add_f32 v[16:17], v[16:17], v[24:25]
    v_pk_add_f32 v[18:19], v[18:19], v[26:27]
    v_pk_add_f32 v[20:21], v[20:21], v[28:29]
    v_pk_add_f32 v[22:23], v[22:23], v[30:31]
    s_waitcnt vmcnt(4)
    v_lshlrev_b32 v24, 16, v108
    v_and_b32 v25, s35, v108
    v_lshlrev_b32 v26, 16, v109
    v_and_b32 v27, s35, v109
    v_lshlrev_b32 v28, 16, v110
    v_and_b32 v29, s35, v110
    v_lshlrev_b32 v30, 16, v111
    v_and_b32 v31, s35, v111
    v_pk_add_f32 v[16:17], v[16:17], v[24:25]
    v_pk_add_f32 v[18:19], v[18:19], v[26:27]
    v_pk_add_f32 v[20:21], v[20:21], v[28:29]
    v_pk_add_f32 v[22:23], v[22:23], v[30:31]
    s_waitcnt vmcnt(3)
    v_lshlrev_b32 v24, 16, v112
    v_and_b32 v25, s35, v112
    v_lshlrev_b32 v26, 16, v113
    v_and_b32 v27, s35, v113
    v_lshlrev_b32 v28, 16, v114
    v_and_b32 v29, s35, v114
    v_lshlrev_b32 v30, 16, v115
    v_and_b32 v31, s35, v115
    v_pk_add_f32 v[16:17], v[16:17], v[24:25]
    v_pk_add_f32 v[18:19], v[18:19], v[26:27]
    v_pk_add_f32 v[20:21], v[20:21], v[28:29]
    v_pk_add_f32 v[22:23], v[22:23], v[30:31]
    s_waitcnt vmcnt(2)
    v_lshlrev_b32 v24, 16, v116
    v_and_b32 v25, s35, v116
    v_lshlrev_b32 v26, 16, v117
    v_and_b32 v27, s35, v117
    v_lshlrev_b32 v28, 16, v118
    v_and_b32 v29, s35, v118
    v_lshlrev_b32 v30, 16, v119
    v_and_b32 v31, s35, v119
    v_pk_add_f32 v[16:17], v[16:17], v[24:25]
    v_pk_add_f32 v[18:19], v[18:19], v[26:27]
    v_pk_add_f32 v[20:21], v[20:21], v[28:29]
    v_pk_add_f32 v[22:23], v[22:23], v[30:31]
    s_waitcnt vmcnt(1)
    v_lshlrev_b32 v24, 16, v120
    v_and_b32 v25, s35, v120
    v_lshlrev_b32 v26, 16, v121
    v_and_b32 v27, s35, v121
    v_lshlrev_b32 v28, 16, v122
    v_and_b32 v29, s35, v122
    v_lshlrev_b32 v30, 16, v123
    v_and_b32 v31, s35, v123
    v_pk_add_f32 v[16:17], v[16:17], v[24:25]
    v_pk_add_f32 v[18:19], v[18:19], v[26:27]
    v_pk_add_f32 v[20:21], v[20:21], v[28:29]
    v_pk_add_f32 v[22:23], v[22:23], v[30:31]
    s_waitcnt vmcnt(0)
    v_lshlrev_b32 v24, 16, v124
    v_and_b32 v25, s35, v124
    v_lshlrev_b32 v26, 16, v125
    v_and_b32 v27, s35, v125
    v_lshlrev_b32 v28, 16, v126
    v_and_b32 v29, s35, v126
    v_lshlrev_b32 v30, 16, v127
    v_and_b32 v31, s35, v127
    v_pk_add_f32 v[16:17], v[16:17], v[24:25]
    v_pk_add_f32 v[18:19], v[18:19], v[26:27]
    v_pk_add_f32 v[20:21], v[20:21], v[28:29]
    v_pk_add_f32 v[22:23], v[22:23], v[30:31]
    v_fmac_f32 v8, v16, v237
    v_fmac_f32 v9, v17, v237
    v_fmac_f32 v10, v18, v237
    v_fmac_f32 v11, v19, v237
    v_fmac_f32 v12, v20, v237
    v_fmac_f32 v13, v21, v237
    v_fmac_f32 v14, v22, v237
    v_fmac_f32 v15, v23, v237
    v_cvt_pk_bf16_f32 v16, v8, v9
    v_cvt_pk_bf16_f32 v17, v10, v11
    v_cvt_pk_bf16_f32 v18, v12, v13
    v_cvt_pk_bf16_f32 v19, v14, v15
    s_nop 1
    v_permlane16_swap_b32 v16, v18
    v_permlane16_swap_b32 v17, v19
    ds_bpermute_b32 v32, v252, v16
    ds_bpermute_b32 v33, v252, v17
    ds_bpermute_b32 v34, v252, v18
    ds_bpermute_b32 v35, v252, v19
    s_waitcnt lgkmcnt(0)
    buffer_store_dwordx4 v[32:35], v251, s[60:63], s10 offen sc1
L_rlx:
    s_endpgm
L_rlw:
    s_waitcnt vmcnt(0)
    s_branch L_rlb
L_rlf:
    s_mov_b32 s7, 0
    s_sub_u32 s12, s12, 8192
L_rlg:
    v_mov_b32 v2, 0
    buffer_atomic_add v2, v253, s[36:39], s12 offen sc0 sc1
    s_waitcnt vmcnt(0)
    v_readfirstlane_b32 s3, v2
    s_nop 0
    s_cmp_ge_u32 s3, 12
    s_cbranch_scc1 L_rlq
    s_sub_u32 s74, s74, 1
    s_cbranch_scc0 L_rlg
    s_mov_b32 s74, 0
    s_branch L_rlq
L_rl1:
    s_cmp_eq_u32 s6, 1
    s_cbranch_scc1 L_rl2
    s_sleep 4
L_late:
    v_mov_b32 v2, 0
    buffer_atomic_add v2, v253, s[36:39], s12 offen sc0 sc1
    buffer_load_dword v3, v254, s[36:39], s14 offen sc1
    s_waitcnt vmcnt(0)
    s_sub_u32 s74, s74, 1
    s_cbranch_scc0 L_rlc
    s_mov_b32 s74, 0
L_rl2:
    s_mov_b32 s64, s8
    buffer_load_dwordx4 v[80:83], v248, s[36:39], s64 offen sc1
    s_add_u32 s64, s64, 4096
    buffer_load_dwordx4 v[84:87], v248, s[36:39], s64 offen sc1
    s_add_u32 s64, s64, 4096
    buffer_load_dwordx4 v[88:91], v248, s[36:39], s64 offen sc1
    s_add_u32 s64, s64, 4096
    buffer_load_dwordx4 v[92:95], v248, s[36:39], s64 offen sc1
    s_add_u32 s64, s64, 4096
    buffer_load_dwordx4 v[96:99], v248, s[36:39], s64 offen sc1
    s_add_u32 s64, s64, 4096
    buffer_load_dwordx4 v[100:103], v248, s[36:39], s64 offen sc1
    s_add_u32 s64, s64, 4096
    buffer_load_dwordx4 v[104:107], v248, s[36:39], s64 offen sc1
    s_add_u32 s64, s64, 4096
    buffer_load_dwordx4 v[108:111], v248, s[36:39], s64 offen sc1
    s_add_u32 s64, s64, 4096
    buffer_load_dwordx4 v[112:115], v248, s[36:39], s64 offen sc1
    s_add_u32 s64, s64, 4096
    buffer_load_dwordx4 v[116:119], v248, s[36:39], s64 offen sc1
    s_add_u32 s64, s64, 4096
    buffer_load_dwordx4 v[120:123], v248, s[36:39], s64 offen sc1
    s_add_u32 s64, s64, 4096
    buffer_load_dwordx4 v[124:127], v248, s[36:39], s64 offen sc1
L_rl3:
    buffer_load_dword v3, v254, s[36:39], s14 offen sc1
    s_mov_b32 s6, 1
    s_waitcnt vmcnt(0)
    v_cmp_le_u32 vcc, 1, v3
    s_nop 0
    s_cmp_eq_u32 vcc_lo, 0xff
    s_cbranch_scc1 L_rly
    s_sleep 4
    s_sub_u32 s74, s74, 1
    s_cbranch_scc0 L_rl3
    s_mov_b32 s74, 0
    s_branch L_rly
L_other:
    s_and_b32 s35, s35, 7
    s_lshl_b32 s30, s34, 3
    s_add_u32 s30, s30, s35
    v_mov_b32 v2, 155648
    v_mov_b32 v3, 0
    ds_write_b32 v2, v3
    s_and_b32 s48, s28, 3
    s_lshl_b32 s50, s30, 3
    s_add_u32 s50, s50, s48
    s_lshr_b32 s33, s30, 2
    s_lshl_b32 s49, s33, 2
    s_add_u32 s49, s49, s48
    s_add_u32 s49, s49, 512
    s_add_u32 s48, s50, 4
    s_add_u32 s51, s30, 1
    s_lshr_b32 s51, s51, 2
    s_sub_u32 s51, s30, s51
    s_and_b32 s31, s35, 3
    s_cmp_eq_u32 s31, 2
    s_cselect_b32 s29, 1, 0
    s_cselect_b32 s33, s33, s51
    s_mov_b32 s75, 3
    s_waitcnt lgkmcnt(0)
    s_cselect_b32 s16, s49, s48
    s_add_u32 s17, s29, 2
    s_barrier
    s_cmp_ge_u32 s28, 4
    s_cbranch_scc1 L_duty
    s_cmp_lg_u32 s28, 3
    s_cbranch_scc1 L_cm0
    s_lshr_b32 s48, s34, 1
    s_mul_i32 s48, s48, 36
    s_bfe_u32 s49, s30, 0x20002
    s_add_u32 s48, s48, s49
    s_add_u32 s48, s48, 32
    s_cmp_eq_u32 s31, 0
    s_cbranch_scc1 L_cs
    s_sub_u32 s66, s31, 1
    s_getpc_b64 s[68:69]
L_pf_L_cm0:
    s_add_u32 s68, s68, L_cm0-L_pf_L_cm0
    s_addc_u32 s69, s69, 0
    v_lshlrev_b32 v224, 7, v0
    s_and_b32 s70, s66, 3
    s_lshl_b32 s70, s70, 13
    v_add_u32 v224, s70, v224
    s_mov_b32 s70, L_mexit-L_cm0
    v_min_u32 v225, s70, v224
    v_mov_b32 v227, s69
    v_add_co_u32 v226, vcc, s68, v225
    s_nop 1
    v_addc_co_u32 v227, vcc, 0, v227, vcc
    global_load_dword v228, v[226:227], off
L_cm0:
    s_mov_b32 s48, 8
    s_lshr_b32 s31, s30, 1
    s_and_b32 s65, s30, 1
    s_cmp_eq_u32 s28, 2
    s_cselect_b32 s65, s65, 0
    s_cmp_eq_u32 s65, 1
    s_cbranch_scc1 L_kv
L_kv0:
    s_barrier
L_kv1:
    s_lshr_b32 s48, s30, 3
    s_and_b32 s31, s30, 7
    s_lshl_b32 s31, s31, 2
    s_add_u32 s31, s31, s28
L_kv:
    s_lshl_b32 s34, s31, 3
    v_lshrrev_b32 v8, 3, v0
    v_add_u32 v1, s34, v8
    v_and_b32 v2, 7, v0
    s_lshl_b32 s35, s48, 7
    v_mul_u32_u24 v3, 9216, v1
    v_lshlrev_b32 v4, 4, v2
    v_add3_u32 v3, v3, v4, s35
    v_subrev_u32 v4, 3456, v3
    v_cmp_eq_u32 vcc, 0, v1
    v_bfrev_b32 v5, 1
    s_movk_i32 s49, 4608
    v_lshlrev_b32 v6, 4, v0
    v_cndmask_b32 v4, v4, v5, vcc
    s_lshl_b32 s68, s28, 10
    s_add_u32 s68, s68, 65536
    s_mov_b32 m0, s68
    s_lshl_b32 s69, s48, 9
    s_mov_b32 s36, s6
    s_mov_b32 s37, s7
    s_mov_b32 s38, 2359296
    s_mov_b32 s39, 0x20000
    s_mov_b32 s44, s10
    s_mov_b32 s45, s11
    s_mov_b32 s46, 4608
    s_mov_b32 s47, 0x20000
    buffer_load_dwordx4 v6, s[44:47], s69 offen lds
    buffer_load_dwordx4 v[28:31], v3, s[36:39], 0 offen offset:0
    buffer_load_dwordx4 v[32:35], v3, s[36:39], 0 offen offset:1152
    buffer_load_dwordx4 v[36:39], v3, s[36:39], 0 offen offset:2304
    buffer_load_dwordx4 v[40:43], v3, s[36:39], 0 offen offset:3456
    buffer_load_dwordx4 v[44:47], v3, s[36:39], s49 offen offset:0
    buffer_load_dwordx4 v[48:51], v3, s[36:39], s49 offen offset:1152
    buffer_load_dwordx4 v[52:55], v3, s[36:39], s49 offen offset:2304
    buffer_load_dwordx4 v[56:59], v3, s[36:39], s49 offen offset:3456
    buffer_load_dwordx4 v[16:19], v4, s[36:39], 0 offen offset:0
    buffer_load_dwordx4 v[20:23], v4, s[36:39], 0 offen offset:1152
    buffer_load_dwordx4 v[24:27], v4, s[36:39], 0 offen offset:2304
    s_mov_b32 s40, s8
    s_mov_b32 s41, s9
    s_mov_b32 s42, 2359296
    s_mov_b32 s43, 0x20000
    buffer_load_dwordx4 v[60:63], v3, s[40:43], 0 offen offset:0
    buffer_load_dwordx4 v[64:67], v3, s[40:43], 0 offen offset:1152
    buffer_load_dwordx4 v[68:71], v3, s[40:43], 0 offen offset:2304
    buffer_load_dwordx4 v[72:75], v3, s[40:43], 0 offen offset:3456
    buffer_load_dwordx4 v[76:79], v3, s[40:43], s49 offen offset:0
    buffer_load_dwordx4 v[80:83], v3, s[40:43], s49 offen offset:1152
    buffer_load_dwordx4 v[84:87], v3, s[40:43], s49 offen offset:2304
    buffer_load_dwordx4 v[88:91], v3, s[40:43], s49 offen offset:3456
    s_mov_b32 s52, s12
    s_mov_b32 s53, s13
    s_mov_b32 s54, 2359296
    s_mov_b32 s55, 0x20000
    s_add_u32 s56, s26, 28311552
    s_addc_u32 s57, s27, 0
    s_mov_b32 s58, 4882176
    s_mov_b32 s59, 0x20000
    v_lshl_add_u32 v9, v2, 6, s68
    v_sub_u32 v7, 7, v8
    v_xor_b32 v7, v7, v2
    v_lshlrev_b32 v7, 4, v7
    v_lshl_add_u32 v7, v2, 10, v7
    s_lshl_b32 s68, s28, 13
    v_add_u32 v7, s68, v7
    v_add_u32 v6, s68, v6
    v_lshlrev_b32 v8, 12, v8
    v_lshl_add_u32 v8, v2, 4, v8
    s_lshl_b32 s61, s48, 18
    s_sub_u32 s31, 31, s31
    s_lshl_b32 s31, s31, 7
    s_add_u32 s61, s61, s31
    s_add_u32 s61, s61, 2522880
    s_mov_b32 s35, 0xffff0000
    s_waitcnt vmcnt(19)
    s_cmp_lg_u32 s65, -2
    s_cbranch_scc1 L_kvs
    s_mov_b64 exec, 1
    v_mov_b32 v10, 155648
    v_mov_b32 v11, 1
    ds_add_u32 v10, v11
    s_mov_b64 exec, -1
    s_mov_b32 s65, 0
L_kvs:
    s_cmp_lg_u32 s65, -4
    s_cbranch_scc1 L_kvt
    s_mov_b64 exec, 1
    v_mov_b32 v10, 0
    v_mov_b32 v11, 1
    global_atomic_add v10, v11, s[24:25] offset:36 sc1
    s_mov_b64 exec, -1
L_kvt:
    ds_read_b128 v[92:95], v9 offset:0
    ds_read_b128 v[96:99], v9 offset:16
    ds_read_b128 v[100:103], v9 offset:32
    ds_read_b128 v[104:107], v9 offset:48
    s_waitcnt vmcnt(8) lgkmcnt(0)
    v_lshlrev_b32 v130, 16, v92
    v_and_b32 v132, s35, v92
    v_lshlrev_b32 v134, 16, v93
    v_and_b32 v136, s35, v93
    v_lshlrev_b32 v131, 16, v94
    v_and_b32 v133, s35, v94
    v_lshlrev_b32 v135, 16, v95
    v_and_b32 v137, s35, v95
    v_lshlrev_b32 v108, 16, v16
    v_and_b32 v109, s35, v16
    v_lshlrev_b32 v110, 16, v20
    v_and_b32 v111, s35, v20
    v_lshlrev_b32 v112, 16, v24
    v_and_b32 v113, s35, v24
    v_lshlrev_b32 v114, 16, v28
    v_and_b32 v115, s35, v28
    v_lshlrev_b32 v116, 16, v32
    v_and_b32 v117, s35, v32
    v_lshlrev_b32 v118, 16, v36
    v_and_b32 v119, s35, v36
    v_lshlrev_b32 v120, 16, v40
    v_and_b32 v121, s35, v40
    v_lshlrev_b32 v122, 16, v44
    v_and_b32 v123, s35, v44
    v_lshlrev_b32 v124, 16, v48
    v_and_b32 v125, s35, v48
    v_lshlrev_b32 v126, 16, v52
    v_and_b32 v127, s35, v52
    v_lshlrev_b32 v128, 16, v56
    v_and_b32 v129, s35, v56
    v_pk_mul_f32 v[140:141], v[108:109], v[136:137]
    v_pk_mul_f32 v[142:143], v[110:111], v[136:137]
    v_pk_mul_f32 v[144:145], v[112:113], v[136:137]
    v_pk_mul_f32 v[146:147], v[114:115], v[136:137]
    v_pk_mul_f32 v[148:149], v[116:117], v[136:137]
    v_pk_mul_f32 v[150:151], v[118:119], v[136:137]
    v_pk_mul_f32 v[152:153], v[120:121], v[136:137]
    v_pk_mul_f32 v[154:155], v[122:123], v[136:137]
    v_pk_fma_f32 v[140:141], v[110:111], v[134:135], v[140:141]
    v_pk_fma_f32 v[142:143], v[112:113], v[134:135], v[142:143]
    v_pk_fma_f32 v[144:145], v[114:115], v[134:135], v[144:145]
    v_pk_fma_f32 v[146:147], v[116:117], v[134:135], v[146:147]
    v_pk_fma_f32 v[148:149], v[118:119], v[134:135], v[148:149]
    v_pk_fma_f32 v[150:151], v[120:121], v[134:135], v[150:151]
    v_pk_fma_f32 v[152:153], v[122:123], v[134:135], v[152:153]
    v_pk_fma_f32 v[154:155], v[124:125], v[134:135], v[154:155]
    v_pk_fma_f32 v[140:141], v[112:113], v[132:133], v[140:141]
    v_pk_fma_f32 v[142:143], v[114:115], v[132:133], v[142:143]
    v_pk_fma_f32 v[144:145], v[116:117], v[132:133], v[144:145]
    v_pk_fma_f32 v[146:147], v[118:119], v[132:133], v[146:147]
    v_pk_fma_f32 v[148:149], v[120:121], v[132:133], v[148:149]
    v_pk_fma_f32 v[150:151], v[122:123], v[132:133], v[150:151]
    v_pk_fma_f32 v[152:153], v[124:125], v[132:133], v[152:153]
    v_pk_fma_f32 v[154:155], v[126:127], v[132:133], v[154:155]
    v_pk_fma_f32 v[140:141], v[114:115], v[130:131], v[140:141]
    v_pk_fma_f32 v[142:143], v[116:117], v[130:131], v[142:143]
    v_pk_fma_f32 v[144:145], v[118:119], v[130:131], v[144:145]
    v_pk_fma_f32 v[146:147], v[120:121], v[130:131], v[146:147]
    v_pk_fma_f32 v[148:149], v[122:123], v[130:131], v[148:149]
    v_pk_fma_f32 v[150:151], v[124:125], v[130:131], v[150:151]
    v_pk_fma_f32 v[152:153], v[126:127], v[130:131], v[152:153]
    v_pk_fma_f32 v[154:155], v[128:129], v[130:131], v[154:155]
    v_lshlrev_b32 v130, 16, v96
    v_and_b32 v132, s35, v96
    v_lshlrev_b32 v134, 16, v97
    v_and_b32 v136, s35, v97
    v_lshlrev_b32 v131, 16, v98
    v_and_b32 v133, s35, v98
    v_lshlrev_b32 v135, 16, v99
    v_and_b32 v137, s35, v99
    v_lshlrev_b32 v108, 16, v17
    v_and_b32 v109, s35, v17
    v_lshlrev_b32 v110, 16, v21
    v_and_b32 v111, s35, v21
    v_lshlrev_b32 v112, 16, v25
    v_and_b32 v113, s35, v25
    v_lshlrev_b32 v114, 16, v29
    v_and_b32 v115, s35, v29
    v_lshlrev_b32 v116, 16, v33
    v_and_b32 v117, s35, v33
    v_lshlrev_b32 v118, 16, v37
    v_and_b32 v119, s35, v37
    v_lshlrev_b32 v120, 16, v41
    v_and_b32 v121, s35, v41
    v_lshlrev_b32 v122, 16, v45
    v_and_b32 v123, s35, v45
    v_lshlrev_b32 v124, 16, v49
    v_and_b32 v125, s35, v49
    v_lshlrev_b32 v126, 16, v53
    v_and_b32 v127, s35, v53
    v_lshlrev_b32 v128, 16, v57
    v_and_b32 v129, s35, v57
    v_pk_mul_f32 v[156:157], v[108:109], v[136:137]
    v_pk_mul_f32 v[158:159], v[110:111], v[136:137]
    v_pk_mul_f32 v[160:161], v[112:113], v[136:137]
    v_pk_mul_f32 v[162:163], v[114:115], v[136:137]
    v_pk_mul_f32 v[164:165], v[116:117], v[136:137]
    v_pk_mul_f32 v[166:167], v[118:119], v[136:137]
    v_pk_mul_f32 v[168:169], v[120:121], v[136:137]
    v_pk_mul_f32 v[170:171], v[122:123], v[136:137]
    v_pk_fma_f32 v[156:157], v[110:111], v[134:135], v[156:157]
    v_pk_fma_f32 v[158:159], v[112:113], v[134:135], v[158:159]
    v_pk_fma_f32 v[160:161], v[114:115], v[134:135], v[160:161]
    v_pk_fma_f32 v[162:163], v[116:117], v[134:135], v[162:163]
    v_pk_fma_f32 v[164:165], v[118:119], v[134:135], v[164:165]
    v_pk_fma_f32 v[166:167], v[120:121], v[134:135], v[166:167]
    v_pk_fma_f32 v[168:169], v[122:123], v[134:135], v[168:169]
    v_pk_fma_f32 v[170:171], v[124:125], v[134:135], v[170:171]
    v_pk_fma_f32 v[156:157], v[112:113], v[132:133], v[156:157]
    v_pk_fma_f32 v[158:159], v[114:115], v[132:133], v[158:159]
    v_pk_fma_f32 v[160:161], v[116:117], v[132:133], v[160:161]
    v_pk_fma_f32 v[162:163], v[118:119], v[132:133], v[162:163]
    v_pk_fma_f32 v[164:165], v[120:121], v[132:133], v[164:165]
    v_pk_fma_f32 v[166:167], v[122:123], v[132:133], v[166:167]
    v_pk_fma_f32 v[168:169], v[124:125], v[132:133], v[168:169]
    v_pk_fma_f32 v[170:171], v[126:127], v[132:133], v[170:171]
    v_pk_fma_f32 v[156:157], v[114:115], v[130:131], v[156:157]
    v_pk_fma_f32 v[158:159], v[116:117], v[130:131], v[158:159]
    v_pk_fma_f32 v[160:161], v[118:119], v[130:131], v[160:161]
    v_pk_fma_f32 v[162:163], v[120:121], v[130:131], v[162:163]
    v_pk_fma_f32 v[164:165], v[122:123], v[130:131], v[164:165]
    v_pk_fma_f32 v[166:167], v[124:125], v[130:131], v[166:167]
    v_pk_fma_f32 v[168:169], v[126:127], v[130:131], v[168:169]
    v_pk_fma_f32 v[170:171], v[128:129], v[130:131], v[170:171]
    v_lshlrev_b32 v130, 16, v100
    v_and_b32 v132, s35, v100
    v_lshlrev_b32 v134, 16, v101
    v_and_b32 v136, s35, v101
    v_lshlrev_b32 v131, 16, v102
    v_and_b32 v133, s35, v102
    v_lshlrev_b32 v135, 16, v103
    v_and_b32 v137, s35, v103
    v_lshlrev_b32 v108, 16, v18
    v_and_b32 v109, s35, v18
    v_lshlrev_b32 v110, 16, v22
    v_and_b32 v111, s35, v22
    v_lshlrev_b32 v112, 16, v26
    v_and_b32 v113, s35, v26
    v_lshlrev_b32 v114, 16, v30
    v_and_b32 v115, s35, v30
    v_lshlrev_b32 v116, 16, v34
    v_and_b32 v117, s35, v34
    v_lshlrev_b32 v118, 16, v38
    v_and_b32 v119, s35, v38
    v_lshlrev_b32 v120, 16, v42
    v_and_b32 v121, s35, v42
    v_lshlrev_b32 v122, 16, v46
    v_and_b32 v123, s35, v46
    v_lshlrev_b32 v124, 16, v50
    v_and_b32 v125, s35, v50
    v_lshlrev_b32 v126, 16, v54
    v_and_b32 v127, s35, v54
    v_lshlrev_b32 v128, 16, v58
    v_and_b32 v129, s35, v58
    v_pk_mul_f32 v[172:173], v[108:109], v[136:137]
    v_pk_mul_f32 v[174:175], v[110:111], v[136:137]
    v_pk_mul_f32 v[176:177], v[112:113], v[136:137]
    v_pk_mul_f32 v[178:179], v[114:115], v[136:137]
    v_pk_mul_f32 v[180:181], v[116:117], v[136:137]
    v_pk_mul_f32 v[182:183], v[118:119], v[136:137]
    v_pk_mul_f32 v[184:185], v[120:121], v[136:137]
    v_pk_mul_f32 v[186:187], v[122:123], v[136:137]
    v_pk_fma_f32 v[172:173], v[110:111], v[134:135], v[172:173]
    v_pk_fma_f32 v[174:175], v[112:113], v[134:135], v[174:175]
    v_pk_fma_f32 v[176:177], v[114:115], v[134:135], v[176:177]
    v_pk_fma_f32 v[178:179], v[116:117], v[134:135], v[178:179]
    v_pk_fma_f32 v[180:181], v[118:119], v[134:135], v[180:181]
    v_pk_fma_f32 v[182:183], v[120:121], v[134:135], v[182:183]
    v_pk_fma_f32 v[184:185], v[122:123], v[134:135], v[184:185]
    v_pk_fma_f32 v[186:187], v[124:125], v[134:135], v[186:187]
    v_pk_fma_f32 v[172:173], v[112:113], v[132:133], v[172:173]
    v_pk_fma_f32 v[174:175], v[114:115], v[132:133], v[174:175]
    v_pk_fma_f32 v[176:177], v[116:117], v[132:133], v[176:177]
    v_pk_fma_f32 v[178:179], v[118:119], v[132:133], v[178:179]
    v_pk_fma_f32 v[180:181], v[120:121], v[132:133], v[180:181]
    v_pk_fma_f32 v[182:183], v[122:123], v[132:133], v[182:183]
    v_pk_fma_f32 v[184:185], v[124:125], v[132:133], v[184:185]
    v_pk_fma_f32 v[186:187], v[126:127], v[132:133], v[186:187]
    v_pk_fma_f32 v[172:173], v[114:115], v[130:131], v[172:173]
    v_pk_fma_f32 v[174:175], v[116:117], v[130:131], v[174:175]
    v_pk_fma_f32 v[176:177], v[118:119], v[130:131], v[176:177]
    v_pk_fma_f32 v[178:179], v[120:121], v[130:131], v[178:179]
    v_pk_fma_f32 v[180:181], v[122:123], v[130:131], v[180:181]
    v_pk_fma_f32 v[182:183], v[124:125], v[130:131], v[182:183]
    v_pk_fma_f32 v[184:185], v[126:127], v[130:131], v[184:185]
    v_pk_fma_f32 v[186:187], v[128:129], v[130:131], v[186:187]
    v_lshlrev_b32 v130, 16, v104
    v_and_b32 v132, s35, v104
    v_lshlrev_b32 v134, 16, v105
    v_and_b32 v136, s35, v105
    v_lshlrev_b32 v131, 16, v106
    v_and_b32 v133, s35, v106
    v_lshlrev_b32 v135, 16, v107
    v_and_b32 v137, s35, v107
    v_lshlrev_b32 v108, 16, v19
    v_and_b32 v109, s35, v19
    v_lshlrev_b32 v110, 16, v23
    v_and_b32 v111, s35, v23
    v_lshlrev_b32 v112, 16, v27
    v_and_b32 v113, s35, v27
    v_lshlrev_b32 v114, 16, v31
    v_and_b32 v115, s35, v31
    v_lshlrev_b32 v116, 16, v35
    v_and_b32 v117, s35, v35
    v_lshlrev_b32 v118, 16, v39
    v_and_b32 v119, s35, v39
    v_lshlrev_b32 v120, 16, v43
    v_and_b32 v121, s35, v43
    v_lshlrev_b32 v122, 16, v47
    v_and_b32 v123, s35, v47
    v_lshlrev_b32 v124, 16, v51
    v_and_b32 v125, s35, v51
    v_lshlrev_b32 v126, 16, v55
    v_and_b32 v127, s35, v55
    v_lshlrev_b32 v128, 16, v59
    v_and_b32 v129, s35, v59
    v_pk_mul_f32 v[188:189], v[108:109], v[136:137]
    v_pk_mul_f32 v[190:191], v[110:111], v[136:137]
    v_pk_mul_f32 v[192:193], v[112:113], v[136:137]
    v_pk_mul_f32 v[194:195], v[114:115], v[136:137]
    v_pk_mul_f32 v[196:197], v[116:117], v[136:137]
    v_pk_mul_f32 v[198:199], v[118:119], v[136:137]
    v_pk_mul_f32 v[200:201], v[120:121], v[136:137]
    v_pk_mul_f32 v[202:203], v[122:123], v[136:137]
    v_pk_fma_f32 v[188:189], v[110:111], v[134:135], v[188:189]
    v_pk_fma_f32 v[190:191], v[112:113], v[134:135], v[190:191]
    v_pk_fma_f32 v[192:193], v[114:115], v[134:135], v[192:193]
    v_pk_fma_f32 v[194:195], v[116:117], v[134:135], v[194:195]
    v_pk_fma_f32 v[196:197], v[118:119], v[134:135], v[196:197]
    v_pk_fma_f32 v[198:199], v[120:121], v[134:135], v[198:199]
    v_pk_fma_f32 v[200:201], v[122:123], v[134:135], v[200:201]
    v_pk_fma_f32 v[202:203], v[124:125], v[134:135], v[202:203]
    v_pk_fma_f32 v[188:189], v[112:113], v[132:133], v[188:189]
    v_pk_fma_f32 v[190:191], v[114:115], v[132:133], v[190:191]
    v_pk_fma_f32 v[192:193], v[116:117], v[132:133], v[192:193]
    v_pk_fma_f32 v[194:195], v[118:119], v[132:133], v[194:195]
    v_pk_fma_f32 v[196:197], v[120:121], v[132:133], v[196:197]
    v_pk_fma_f32 v[198:199], v[122:123], v[132:133], v[198:199]
    v_pk_fma_f32 v[200:201], v[124:125], v[132:133], v[200:201]
    v_pk_fma_f32 v[202:203], v[126:127], v[132:133], v[202:203]
    v_pk_fma_f32 v[188:189], v[114:115], v[130:131], v[188:189]
    v_pk_fma_f32 v[190:191], v[116:117], v[130:131], v[190:191]
    v_pk_fma_f32 v[192:193], v[118:119], v[130:131], v[192:193]
    v_pk_fma_f32 v[194:195], v[120:121], v[130:131], v[194:195]
    v_pk_fma_f32 v[196:197], v[122:123], v[130:131], v[196:197]
    v_pk_fma_f32 v[198:199], v[124:125], v[130:131], v[198:199]
    v_pk_fma_f32 v[200:201], v[126:127], v[130:131], v[200:201]
    v_pk_fma_f32 v[202:203], v[128:129], v[130:131], v[202:203]
    s_waitcnt vmcnt(0)
    v_lshlrev_b32 v108, 16, v60
    v_and_b32 v109, s35, v60
    v_lshlrev_b32 v110, 16, v64
    v_and_b32 v111, s35, v64
    v_lshlrev_b32 v112, 16, v68
    v_and_b32 v113, s35, v68
    v_lshlrev_b32 v114, 16, v72
    v_and_b32 v115, s35, v72
    v_lshlrev_b32 v116, 16, v76
    v_and_b32 v117, s35, v76
    v_lshlrev_b32 v118, 16, v80
    v_and_b32 v119, s35, v80
    v_lshlrev_b32 v120, 16, v84
    v_and_b32 v121, s35, v84
    v_lshlrev_b32 v122, 16, v88
    v_and_b32 v123, s35, v88
    v_pk_mul_f32 v[140:141], v[140:141], v[108:109]
    v_pk_mul_f32 v[142:143], v[142:143], v[110:111]
    v_pk_mul_f32 v[144:145], v[144:145], v[112:113]
    v_pk_mul_f32 v[146:147], v[146:147], v[114:115]
    v_pk_mul_f32 v[148:149], v[148:149], v[116:117]
    v_pk_mul_f32 v[150:151], v[150:151], v[118:119]
    v_pk_mul_f32 v[152:153], v[152:153], v[120:121]
    v_pk_mul_f32 v[154:155], v[154:155], v[122:123]
    v_cvt_pk_bf16_f32 v204, v154, v152
    v_cvt_pk_bf16_f32 v205, v150, v148
    v_cvt_pk_bf16_f32 v206, v146, v144
    v_cvt_pk_bf16_f32 v207, v142, v140
    ds_write_b128 v7, v[204:207] offset:0
    v_cvt_pk_bf16_f32 v208, v155, v153
    v_cvt_pk_bf16_f32 v209, v151, v149
    v_cvt_pk_bf16_f32 v210, v147, v145
    v_cvt_pk_bf16_f32 v211, v143, v141
    ds_write_b128 v7, v[208:211] offset:128
    v_lshlrev_b32 v108, 16, v61
    v_and_b32 v109, s35, v61
    v_lshlrev_b32 v110, 16, v65
    v_and_b32 v111, s35, v65
    v_lshlrev_b32 v112, 16, v69
    v_and_b32 v113, s35, v69
    v_lshlrev_b32 v114, 16, v73
    v_and_b32 v115, s35, v73
    v_lshlrev_b32 v116, 16, v77
    v_and_b32 v117, s35, v77
    v_lshlrev_b32 v118, 16, v81
    v_and_b32 v119, s35, v81
    v_lshlrev_b32 v120, 16, v85
    v_and_b32 v121, s35, v85
    v_lshlrev_b32 v122, 16, v89
    v_and_b32 v123, s35, v89
    v_pk_mul_f32 v[156:157], v[156:157], v[108:109]
    v_pk_mul_f32 v[158:159], v[158:159], v[110:111]
    v_pk_mul_f32 v[160:161], v[160:161], v[112:113]
    v_pk_mul_f32 v[162:163], v[162:163], v[114:115]
    v_pk_mul_f32 v[164:165], v[164:165], v[116:117]
    v_pk_mul_f32 v[166:167], v[166:167], v[118:119]
    v_pk_mul_f32 v[168:169], v[168:169], v[120:121]
    v_pk_mul_f32 v[170:171], v[170:171], v[122:123]
    v_cvt_pk_bf16_f32 v212, v170, v168
    v_cvt_pk_bf16_f32 v213, v166, v164
    v_cvt_pk_bf16_f32 v214, v162, v160
    v_cvt_pk_bf16_f32 v215, v158, v156
    ds_write_b128 v7, v[212:215] offset:256
    v_cvt_pk_bf16_f32 v216, v171, v169
    v_cvt_pk_bf16_f32 v217, v167, v165
    v_cvt_pk_bf16_f32 v218, v163, v161
    v_cvt_pk_bf16_f32 v219, v159, v157
    ds_write_b128 v7, v[216:219] offset:384
    v_lshlrev_b32 v108, 16, v62
    v_and_b32 v109, s35, v62
    v_lshlrev_b32 v110, 16, v66
    v_and_b32 v111, s35, v66
    v_lshlrev_b32 v112, 16, v70
    v_and_b32 v113, s35, v70
    v_lshlrev_b32 v114, 16, v74
    v_and_b32 v115, s35, v74
    v_lshlrev_b32 v116, 16, v78
    v_and_b32 v117, s35, v78
    v_lshlrev_b32 v118, 16, v82
    v_and_b32 v119, s35, v82
    v_lshlrev_b32 v120, 16, v86
    v_and_b32 v121, s35, v86
    v_lshlrev_b32 v122, 16, v90
    v_and_b32 v123, s35, v90
    v_pk_mul_f32 v[172:173], v[172:173], v[108:109]
    v_pk_mul_f32 v[174:175], v[174:175], v[110:111]
    v_pk_mul_f32 v[176:177], v[176:177], v[112:113]
    v_pk_mul_f32 v[178:179], v[178:179], v[114:115]
    v_pk_mul_f32 v[180:181], v[180:181], v[116:117]
    v_pk_mul_f32 v[182:183], v[182:183], v[118:119]
    v_pk_mul_f32 v[184:185], v[184:185], v[120:121]
    v_pk_mul_f32 v[186:187], v[186:187], v[122:123]
    v_cvt_pk_bf16_f32 v204, v186, v184
    v_cvt_pk_bf16_f32 v205, v182, v180
    v_cvt_pk_bf16_f32 v206, v178, v176
    v_cvt_pk_bf16_f32 v207, v174, v172
    ds_write_b128 v7, v[204:207] offset:512
    v_cvt_pk_bf16_f32 v208, v187, v185
    v_cvt_pk_bf16_f32 v209, v183, v181
    v_cvt_pk_bf16_f32 v210, v179, v177
    v_cvt_pk_bf16_f32 v211, v175, v173
    ds_write_b128 v7, v[208:211] offset:640
    v_lshlrev_b32 v108, 16, v63
    v_and_b32 v109, s35, v63
    v_lshlrev_b32 v110, 16, v67
    v_and_b32 v111, s35, v67
    v_lshlrev_b32 v112, 16, v71
    v_and_b32 v113, s35, v71
    v_lshlrev_b32 v114, 16, v75
    v_and_b32 v115, s35, v75
    v_lshlrev_b32 v116, 16, v79
    v_and_b32 v117, s35, v79
    v_lshlrev_b32 v118, 16, v83
    v_and_b32 v119, s35, v83
    v_lshlrev_b32 v120, 16, v87
    v_and_b32 v121, s35, v87
    v_lshlrev_b32 v122, 16, v91
    v_and_b32 v123, s35, v91
    v_pk_mul_f32 v[188:189], v[188:189], v[108:109]
    v_pk_mul_f32 v[190:191], v[190:191], v[110:111]
    v_pk_mul_f32 v[192:193], v[192:193], v[112:113]
    v_pk_mul_f32 v[194:195], v[194:195], v[114:115]
    v_pk_mul_f32 v[196:197], v[196:197], v[116:117]
    v_pk_mul_f32 v[198:199], v[198:199], v[118:119]
    v_pk_mul_f32 v[200:201], v[200:201], v[120:121]
    v_pk_mul_f32 v[202:203], v[202:203], v[122:123]
    v_cvt_pk_bf16_f32 v212, v202, v200
    v_cvt_pk_bf16_f32 v213, v198, v196
    v_cvt_pk_bf16_f32 v214, v194, v192
    v_cvt_pk_bf16_f32 v215, v190, v188
    ds_write_b128 v7, v[212:215] offset:768
    v_cvt_pk_bf16_f32 v216, v203, v201
    v_cvt_pk_bf16_f32 v217, v199, v197
    v_cvt_pk_bf16_f32 v218, v195, v193
    v_cvt_pk_bf16_f32 v219, v191, v189
    ds_write_b128 v7, v[216:219] offset:896
    ds_read_b128 v[16:19], v6 offset:0
    ds_read_b128 v[20:23], v6 offset:1024
    ds_read_b128 v[24:27], v6 offset:2048
    ds_read_b128 v[28:31], v6 offset:3072
    ds_read_b128 v[32:35], v6 offset:4096
    ds_read_b128 v[36:39], v6 offset:5120
    ds_read_b128 v[40:43], v6 offset:6144
    ds_read_b128 v[44:47], v6 offset:7168
    v_xor_b32 v9, 0, v8
    s_waitcnt lgkmcnt(7)
    buffer_store_dwordx4 v[16:19], v9, s[56:59], s61 offen sc1
    s_add_u32 s61, s61, 32768
    v_xor_b32 v9, 16, v8
    s_waitcnt lgkmcnt(6)
    buffer_store_dwordx4 v[20:23], v9, s[56:59], s61 offen sc1
    s_add_u32 s61, s61, 32768
    v_xor_b32 v9, 32, v8
    s_waitcnt lgkmcnt(5)
    buffer_store_dwordx4 v[24:27], v9, s[56:59], s61 offen sc1
    s_add_u32 s61, s61, 32768
    v_xor_b32 v9, 48, v8
    s_waitcnt lgkmcnt(4)
    buffer_store_dwordx4 v[28:31], v9, s[56:59], s61 offen sc1
    s_add_u32 s61, s61, 32768
    v_xor_b32 v9, 64, v8
    s_waitcnt lgkmcnt(3)
    buffer_store_dwordx4 v[32:35], v9, s[56:59], s61 offen sc1
    s_add_u32 s61, s61, 32768
    v_xor_b32 v9, 80, v8
    s_waitcnt lgkmcnt(2)
    buffer_store_dwordx4 v[36:39], v9, s[56:59], s61 offen sc1
    s_add_u32 s61, s61, 32768
    v_xor_b32 v9, 96, v8
    s_waitcnt lgkmcnt(1)
    buffer_store_dwordx4 v[40:43], v9, s[56:59], s61 offen sc1
    s_add_u32 s61, s61, 32768
    v_xor_b32 v9, 112, v8
    s_waitcnt lgkmcnt(0)
    buffer_store_dwordx4 v[44:47], v9, s[56:59], s61 offen sc1
    s_add_u32 s61, s61, 32768
    s_cmp_eq_u32 s65, 1
    s_mov_b32 s65, -4
    s_cbranch_scc1 L_kv0
    s_lshl_b32 s62, s50, 1
    s_and_b32 s62, s62, -4
    s_load_dword s18, s[14:15], s62
    s_add_u32 s62, s62, 8
    s_load_dword s19, s[14:15], s62
    s_lshl_b32 s62, s16, 1
    s_and_b32 s62, s62, -4
    s_load_dword s20, s[14:15], s62
    v_and_b32 v9, 15, v0
    v_lshrrev_b32 v10, 4, v0
    v_lshl_add_u32 v11, v10, 3, v9
    v_mov_b32 v12, 0xffff
    v_mov_b32 v13, s35
    v_cmp_le_u32 vcc, 15, v11
    v_cmp_le_u32 s[66:67], 14, v11
    v_mov_b32 v220, 0
    v_cndmask_b32 v14, 0, v12, vcc
    v_cndmask_b32 v15, 0, v13, s[66:67]
    v_cmp_eq_u32 vcc, 15, v11
    v_cmp_eq_u32 s[66:67], 14, v11
    v_or_b32 v240, v14, v15
    v_cndmask_b32 v14, 0, v12, vcc
    v_cndmask_b32 v15, 0, v13, s[66:67]
    v_or_b32 v244, v14, v15
    v_cmp_le_u32 vcc, 13, v11
    v_cmp_le_u32 s[66:67], 12, v11
    v_mov_b32 v221, 0
    v_cndmask_b32 v14, 0, v12, vcc
    v_cndmask_b32 v15, 0, v13, s[66:67]
    v_cmp_eq_u32 vcc, 13, v11
    v_cmp_eq_u32 s[66:67], 12, v11
    v_or_b32 v241, v14, v15
    v_cndmask_b32 v14, 0, v12, vcc
    v_cndmask_b32 v15, 0, v13, s[66:67]
    v_or_b32 v245, v14, v15
    v_cmp_le_u32 vcc, 11, v11
    v_cmp_le_u32 s[66:67], 10, v11
    v_mov_b32 v222, 0
    v_cndmask_b32 v14, 0, v12, vcc
    v_cndmask_b32 v15, 0, v13, s[66:67]
    v_cmp_eq_u32 vcc, 11, v11
    v_cmp_eq_u32 s[66:67], 10, v11
    v_or_b32 v242, v14, v15
    v_cndmask_b32 v14, 0, v12, vcc
    v_cndmask_b32 v15, 0, v13, s[66:67]
    v_or_b32 v246, v14, v15
    v_cmp_le_u32 vcc, 9, v11
    v_cmp_le_u32 s[66:67], 8, v11
    v_mov_b32 v223, 0
    v_cndmask_b32 v14, 0, v12, vcc
    v_cndmask_b32 v15, 0, v13, s[66:67]
    v_cmp_eq_u32 vcc, 9, v11
    v_cmp_eq_u32 s[66:67], 8, v11
    v_or_b32 v243, v14, v15
    v_cndmask_b32 v14, 0, v12, vcc
    v_cndmask_b32 v15, 0, v13, s[66:67]
    v_or_b32 v247, v14, v15
    s_cmp_lg_u32 s50, 0
    s_cbranch_scc1 L_cnf
    v_add_u32 v12, -15, v11
    v_cmp_gt_i32 vcc, 0, v12
    v_lshlrev_b32 v12, 1, v12
    s_nop 0
    v_cndmask_b32 v12, v12, v5, vcc
    buffer_load_ushort v64, v12, s[52:55], 0 offen
    v_add_u32 v12, -14, v11
    v_cmp_gt_i32 vcc, 0, v12
    v_lshlrev_b32 v12, 1, v12
    s_nop 0
    v_cndmask_b32 v12, v12, v5, vcc
    buffer_load_ushort v65, v12, s[52:55], 0 offen
    v_add_u32 v12, -13, v11
    v_cmp_gt_i32 vcc, 0, v12
    v_lshlrev_b32 v12, 1, v12
    s_nop 0
    v_cndmask_b32 v12, v12, v5, vcc
    buffer_load_ushort v66, v12, s[52:55], 0 offen
    v_add_u32 v12, -12, v11
    v_cmp_gt_i32 vcc, 0, v12
    v_lshlrev_b32 v12, 1, v12
    s_nop 0
    v_cndmask_b32 v12, v12, v5, vcc
    buffer_load_ushort v67, v12, s[52:55], 0 offen
    v_add_u32 v12, -11, v11
    v_cmp_gt_i32 vcc, 0, v12
    v_lshlrev_b32 v12, 1, v12
    s_nop 0
    v_cndmask_b32 v12, v12, v5, vcc
    buffer_load_ushort v68, v12, s[52:55], 0 offen
    v_add_u32 v12, -10, v11
    v_cmp_gt_i32 vcc, 0, v12
    v_lshlrev_b32 v12, 1, v12
    s_nop 0
    v_cndmask_b32 v12, v12, v5, vcc
    buffer_load_ushort v69, v12, s[52:55], 0 offen
    v_add_u32 v12, -9, v11
    v_cmp_gt_i32 vcc, 0, v12
    v_lshlrev_b32 v12, 1, v12
    s_nop 0
    v_cndmask_b32 v12, v12, v5, vcc
    buffer_load_ushort v70, v12, s[52:55], 0 offen
    v_add_u32 v12, -8, v11
    v_cmp_gt_i32 vcc, 0, v12
    v_lshlrev_b32 v12, 1, v12
    s_nop 0
    v_cndmask_b32 v12, v12, v5, vcc
    buffer_load_ushort v71, v12, s[52:55], 0 offen
    s_waitcnt vmcnt(0)
    v_lshl_or_b32 v220, v65, 16, v64
    v_lshl_or_b32 v221, v67, 16, v66
    v_lshl_or_b32 v222, v69, 16, v68
    v_lshl_or_b32 v223, v71, 16, v70
L_cnf:
    s_waitcnt vmcnt(0)
    s_barrier
    s_lshl_b32 s34, s28, 6
    v_add_u32 v8, s34, v0
    v_lshrrev_b32 v9, 5, v8
    v_and_b32 v8, 31, v8
    v_mul_u32_u24 v9, 4608, v9
    v_lshl_add_u32 v8, v8, 4, v9
    v_mov_b32 v12, 0
    v_mov_b32 v13, 0
    v_mov_b32 v14, 0
    v_mov_b32 v15, 0
    ds_write_b128 v8, v[12:15] offset:4096
    ds_write_b128 v8, v[12:15] offset:40960
    v_and_b32 v9, 15, v0
    v_lshrrev_b32 v10, 4, v0
    v_and_b32 v11, 3, v9
    v_mul_u32_u24 v11, 320, v11
    v_and_b32 v12, 12, v9
    v_lshl_add_u32 v12, v10, 3, v12
    v_lshl_add_u32 v11, v12, 1, v11
    s_mul_i32 s60, s28, 20480
    s_add_u32 s60, s60, 73728
    v_add_u32 v2, s60, v11
    s_mul_i32 s60, s28, 4608
    v_lshlrev_b32 v11, 5, v9
    v_sub_u32 v11, s60, v11
    v_lshl_add_u32 v3, v10, 4, v11
    v_add_u32 v3, 480, v3
    v_lshl_add_u32 v6, v0, 4, s60
    s_and_b32 s62, s50, 1
    s_lshl_b32 s62, s62, 4
    s_waitcnt lgkmcnt(0)
    s_lshr_b32 s44, s18, s62
    s_lshr_b32 s45, s19, s62
    s_lshr_b32 s46, s20, s62
    s_pack_ll_b32_b16 s62, s44, s44
    v_and_b32 v12, s62, v244
    v_and_b32 v13, s62, v245
    v_and_b32 v14, s62, v246
    v_and_b32 v15, s62, v247
    s_mov_b32 s44, s45
    s_mov_b32 s45, s46
    s_mov_b64 vcc, 1
    s_cmp_eq_u32 s28, 0
    s_cbranch_scc1 L_cpad0
    s_cmp_eq_u32 s28, 1
    s_cbranch_scc1 L_cpad1
L_cwret:
    s_mov_b64 vcc, 0
    s_barrier
    s_waitcnt lgkmcnt(0)
    s_barrier
    s_branch L_cmf
L_sea:
    s_and_b32 s34, s28, 3
    s_lshl_b32 s51, s50, 12
    s_movk_i32 s32, 16000
    s_mov_b32 s62, 53687092
    s_mov_b32 s63, 214748365
    s_mov_b32 s64, 429496730
    v_add_u32 v9, 0, v0
    v_mul_hi_u32 v10, v9, s62
    v_mul_u32_u24 v11, 80, v10
    v_sub_u32 v9, v9, v11
    v_mul_hi_u32 v11, v9, s63
    v_mul_u32_u24 v12, 20, v11
    v_sub_u32 v9, v9, v12
    v_mul_hi_u32 v12, v9, s64
    v_mul_u32_u24 v13, 10, v12
    v_sub_u32 v9, v9, v13
    v_lshl_add_u32 v10, v10, 1, v12
    v_lshlrev_b32 v10, 8, v10
    v_lshl_add_u32 v10, v9, 3, v10
    v_add3_u32 v10, v10, v11, -15
    v_lshlrev_b32 v10, 1, v10
    v_add_u32 v232, s51, v10
    v_add_u32 v9, 64, v0
    v_mul_hi_u32 v10, v9, s62
    v_mul_u32_u24 v11, 80, v10
    v_sub_u32 v9, v9, v11
    v_mul_hi_u32 v11, v9, s63
    v_mul_u32_u24 v12, 20, v11
    v_sub_u32 v9, v9, v12
    v_mul_hi_u32 v12, v9, s64
    v_mul_u32_u24 v13, 10, v12
    v_sub_u32 v9, v9, v13
    v_lshl_add_u32 v10, v10, 1, v12
    v_lshlrev_b32 v10, 8, v10
    v_lshl_add_u32 v10, v9, 3, v10
    v_add3_u32 v10, v10, v11, -15
    v_lshlrev_b32 v10, 1, v10
    v_add_u32 v233, s51, v10
    v_add_u32 v9, 128, v0
    v_mul_hi_u32 v10, v9, s62
    v_mul_u32_u24 v11, 80, v10
    v_sub_u32 v9, v9, v11
    v_mul_hi_u32 v11, v9, s63
    v_mul_u32_u24 v12, 20, v11
    v_sub_u32 v9, v9, v12
    v_mul_hi_u32 v12, v9, s64
    v_mul_u32_u24 v13, 10, v12
    v_sub_u32 v9, v9, v13
    v_lshl_add_u32 v10, v10, 1, v12
    v_lshlrev_b32 v10, 8, v10
    v_lshl_add_u32 v10, v9, 3, v10
    v_add3_u32 v10, v10, v11, -15
    v_lshlrev_b32 v10, 1, v10
    v_add_u32 v234, s51, v10
    v_add_u32 v9, 192, v0
    v_mul_hi_u32 v10, v9, s62
    v_mul_u32_u24 v11, 80, v10
    v_sub_u32 v9, v9, v11
    v_mul_hi_u32 v11, v9, s63
    v_mul_u32_u24 v12, 20, v11
    v_sub_u32 v9, v9, v12
    v_mul_hi_u32 v12, v9, s64
    v_mul_u32_u24 v13, 10, v12
    v_sub_u32 v9, v9, v13
    v_lshl_add_u32 v10, v10, 1, v12
    v_lshlrev_b32 v10, 8, v10
    v_lshl_add_u32 v10, v9, 3, v10
    v_add3_u32 v10, v10, v11, -15
    v_lshlrev_b32 v10, 1, v10
    v_add_u32 v235, s51, v10
    v_add_u32 v9, 256, v0
    v_mul_hi_u32 v10, v9, s62
    v_mul_u32_u24 v11, 80, v10
    v_sub_u32 v9, v9, v11
    v_mul_hi_u32 v11, v9, s63
    v_mul_u32_u24 v12, 20, v11
    v_sub_u32 v9, v9, v12
    v_mul_hi_u32 v12, v9, s64
    v_mul_u32_u24 v13, 10, v12
    v_sub_u32 v9, v9, v13
    v_lshl_add_u32 v10, v10, 1, v12
    v_lshlrev_b32 v10, 8, v10
    v_lshl_add_u32 v10, v9, 3, v10
    v_add3_u32 v10, v10, v11, -15
    v_lshlrev_b32 v10, 1, v10
    v_add_u32 v236, s51, v10
    s_mul_i32 s60, s34, 20480
    s_add_u32 s60, s60, 73728
    s_add_u32 s56, s26, 28311552
    s_addc_u32 s57, s27, 0
    s_mov_b32 s58, 4882176
    s_mov_b32 s59, 0x20000
    s_waitcnt vmcnt(0)
    s_mov_b64 exec, 1
    v_mov_b32 v10, 155648
    v_mov_b32 v11, 1
    ds_add_u32 v10, v11
    s_mov_b64 exec, -1
    s_add_u32 m0, s60, 0
    s_nop 0
    buffer_load_dwordx4 v232, s[52:55], 0 offen lds
    v_add_u32 v232, 128, v232
    s_add_u32 m0, s60, 1024
    s_nop 0
    buffer_load_dwordx4 v233, s[52:55], 0 offen lds
    v_add_u32 v233, 128, v233
    s_add_u32 m0, s60, 2048
    s_nop 0
    buffer_load_dwordx4 v234, s[52:55], 0 offen lds
    v_add_u32 v234, 128, v234
    s_add_u32 m0, s60, 3072
    s_nop 0
    buffer_load_dwordx4 v235, s[52:55], 0 offen lds
    v_add_u32 v235, 128, v235
    s_add_u32 m0, s60, 4096
    s_nop 0
    buffer_load_dwordx4 v236, s[52:55], 0 offen lds
    v_add_u32 v236, 128, v236
    s_cmp_lg_u32 s28, 6
    s_cbranch_scc1 L_sg4
    s_and_b32 s62, s30, 3
    s_cmp_eq_u32 s62, 0
    s_cselect_b32 s62, 5, 4
    s_mov_b64 exec, 1
L_sg1:
    ds_read_b32 v12, v10
    s_waitcnt lgkmcnt(0)
    v_readfirstlane_b32 s3, v12
    s_nop 0
    s_cmp_ge_u32 s3, s62
    s_cbranch_scc1 L_sg2
    s_sleep 1
    s_sub_u32 s74, s74, 1
    s_cbranch_scc0 L_sg1
    s_mov_b32 s74, 0
L_sg2:
    v_mov_b32 v10, 0
    global_atomic_add v12, v10, v11, s[24:25] sc0 sc1
    s_waitcnt vmcnt(0)
    v_readfirstlane_b32 s3, v12
    s_nop 0
    s_cmp_lg_u32 s3, 63
    s_cbranch_scc1 L_sg3
    global_store_dword v10, v11, s[24:25] offset:128 sc1
L_sg3:
    s_mov_b64 exec, -1
L_sg4:
    s_lshl_b32 s70, s30, 9
    s_movk_i32 s71, 256
    s_lshr_b32 s61, s30, 3
    s_lshl_b32 s61, s61, 2
    s_lshl_b32 s63, s29, 5
    v_mov_b32 v2, 32
    v_mov_b32 v3, 0
    v_mov_b32 v4, s63
    s_mov_b64 exec, 1
    v_mov_b32 v2, s61
    v_mov_b32 v3, 1
    v_mov_b32 v4, 8
    s_mov_b64 exec, -1
    v_lshlrev_b32 v7, 4, v0
    s_add_u32 s61, s51, 2522880
    s_add_u32 s62, s61, 16384
    s_lshl_b32 s63, s16, 12
    s_add_u32 s63, s63, 2522880
    s_mul_i32 s64, s34, 4608
    s_barrier
    s_cmp_lg_u32 s28, 4
    s_cbranch_scc1 L_seq
    s_mov_b64 exec, 3
    global_atomic_add v6, v2, v3, s[24:25] offset:4 sc0 sc1
    s_mov_b64 exec, -1
L_seq:
    s_add_u32 m0, s60, 5120
    s_nop 0
    buffer_load_dwordx4 v232, s[52:55], 0 offen lds
    v_add_u32 v232, 128, v232
    s_add_u32 m0, s60, 6144
    s_nop 0
    buffer_load_dwordx4 v233, s[52:55], 0 offen lds
    v_add_u32 v233, 128, v233
    s_add_u32 m0, s60, 7168
    s_nop 0
    buffer_load_dwordx4 v234, s[52:55], 0 offen lds
    v_add_u32 v234, 128, v234
    s_add_u32 m0, s60, 8192
    s_nop 0
    buffer_load_dwordx4 v235, s[52:55], 0 offen lds
    v_add_u32 v235, 128, v235
    s_add_u32 m0, s60, 9216
    s_nop 0
    buffer_load_dwordx4 v236, s[52:55], 0 offen lds
    v_add_u32 v236, 128, v236
    s_cmp_lg_u32 s28, 4
    s_cbranch_scc1 L_ses
    s_mov_b64 exec, 3
    s_waitcnt vmcnt(5)
L_sep:
    v_add_u32 v6, v6, v3
    v_mov_b32 v3, 0
    v_cmp_ge_u32 vcc, v6, v4
    s_nop 0
    s_cmp_eq_u32 vcc_lo, 3
    s_cbranch_scc1 L_ser
    global_atomic_add v6, v2, v3, s[24:25] offset:4 sc0 sc1
    s_waitcnt vmcnt(0)
    s_sub_u32 s74, s74, 1
    s_cbranch_scc0 L_sep
    s_mov_b32 s74, 0
L_ser:
    s_mov_b64 exec, -1
L_ses:
    s_barrier
    s_add_u32 m0, s64, 0
    s_nop 0
    buffer_load_dwordx4 v7, s[56:59], s61 offen offset:0 sc1 lds
    buffer_load_dwordx4 v7, s[56:59], s61 offen offset:1024 sc1 lds
    buffer_load_dwordx4 v7, s[56:59], s61 offen offset:2048 sc1 lds
    buffer_load_dwordx4 v7, s[56:59], s61 offen offset:3072 sc1 lds
    v_min_u32 v9, 31, v0
    v_lshlrev_b32 v9, 7, v9
    s_add_u32 s48, s51, 16384
    buffer_load_dword v238, v9, s[52:55], s48 offen
    s_mov_b32 s40, s20
    s_mov_b32 s41, s21
    s_mov_b32 s42, 5308416
    s_mov_b32 s43, 0x20000
    s_add_u32 s48, s30, 8
    s_lshr_b32 s48, s48, 4
    s_mul_i32 s48, s48, 6
    s_sub_u32 s48, s33, s48
    s_lshl_b32 s48, s48, 2
    s_add_u32 s48, s48, s34
    s_mul_i32 s48, s48, 55296
    s_cmp_eq_u32 s29, 0
    s_cselect_b32 s42, s42, 0
    s_cselect_b32 s48, s48, 0
    v_min_u32 v8, 47, v0
    v_mul_u32_u24 v8, 1152, v8
    s_waitcnt vmcnt(1)
    s_barrier
    s_add_u32 m0, s60, 10240
    s_nop 0
    buffer_load_dwordx4 v232, s[52:55], 0 offen lds
    v_add_u32 v232, 128, v232
    s_add_u32 m0, s60, 11264
    s_nop 0
    buffer_load_dwordx4 v233, s[52:55], 0 offen lds
    v_add_u32 v233, 128, v233
    s_add_u32 m0, s60, 12288
    s_nop 0
    buffer_load_dwordx4 v234, s[52:55], 0 offen lds
    v_add_u32 v234, 128, v234
    s_add_u32 m0, s60, 13312
    s_nop 0
    buffer_load_dwordx4 v235, s[52:55], 0 offen lds
    v_add_u32 v235, 128, v235
    s_add_u32 m0, s60, 14336
    s_nop 0
    buffer_load_dwordx4 v236, s[52:55], 0 offen lds
    v_add_u32 v236, 128, v236
    s_barrier
    s_add_u32 m0, s60, 15360
    s_nop 0
    buffer_load_dwordx4 v232, s[52:55], 0 offen lds
    v_add_u32 v232, s32, v232
    s_add_u32 m0, s60, 16384
    s_nop 0
    buffer_load_dwordx4 v233, s[52:55], 0 offen lds
    v_add_u32 v233, s32, v233
    s_add_u32 m0, s60, 17408
    s_nop 0
    buffer_load_dwordx4 v234, s[52:55], 0 offen lds
    v_add_u32 v234, s32, v234
    s_add_u32 m0, s60, 18432
    s_nop 0
    buffer_load_dwordx4 v235, s[52:55], 0 offen lds
    v_add_u32 v235, s32, v235
    s_add_u32 m0, s60, 19456
    s_nop 0
    buffer_load_dwordx4 v236, s[52:55], 0 offen lds
    v_add_u32 v236, s32, v236
    s_add_u32 m0, s64, 18432
    s_nop 0
    buffer_load_dwordx4 v7, s[56:59], s62 offen offset:0 sc1 lds
    buffer_load_dwordx4 v7, s[56:59], s62 offen offset:1024 sc1 lds
    buffer_load_dwordx4 v7, s[56:59], s62 offen offset:2048 sc1 lds
    buffer_load_dwordx4 v7, s[56:59], s62 offen offset:3072 sc1 lds
    buffer_load_dword v237, v8, s[40:43], s48 offen offset:1024
    s_lshl_b32 s49, s16, 12
    s_sub_u32 s32, s49, s51
    s_sub_u32 s32, s32, 16768
    s_lshl_b32 s62, s34, 10
    v_lshl_add_u32 v10, v0, 4, s62
    v_lshrrev_b32 v11, 4, v0
    v_mul_u32_u24 v11, 73728, v11
    v_and_b32 v12, 15, v0
    v_lshl_add_u32 v11, v12, 4, v11
    v_bfrev_b32 v4, 1
    s_mov_b64 s[66:67], 1
    v_cndmask_b32 v4, v4, 0, s[66:67]
    s_mul_i32 s62, s34, 589824
    s_add_u32 s70, s70, s62
    s_waitcnt vmcnt(9)
    s_barrier
    s_add_u32 m0, s60, 0
    s_nop 0
    buffer_load_dwordx4 v232, s[52:55], 0 offen lds
    v_add_u32 v232, 128, v232
    s_add_u32 m0, s60, 1024
    s_nop 0
    buffer_load_dwordx4 v233, s[52:55], 0 offen lds
    v_add_u32 v233, 128, v233
    s_add_u32 m0, s60, 2048
    s_nop 0
    buffer_load_dwordx4 v234, s[52:55], 0 offen lds
    v_add_u32 v234, 128, v234
    s_add_u32 m0, s60, 3072
    s_nop 0
    buffer_load_dwordx4 v235, s[52:55], 0 offen lds
    v_add_u32 v235, 128, v235
    s_add_u32 m0, s60, 4096
    s_nop 0
    buffer_load_dwordx4 v236, s[52:55], 0 offen lds
    v_add_u32 v236, 128, v236
    s_mov_b32 s61, 1
    s_branch L_ca3b
L_ca2:
    s_add_u32 m0, s64, 36864
    s_nop 0
    buffer_load_dwordx4 v7, s[56:59], s63 offen offset:0 sc1 lds
    buffer_load_dwordx4 v7, s[56:59], s63 offen offset:1024 sc1 lds
    buffer_load_dwordx4 v7, s[56:59], s63 offen offset:2048 sc1 lds
    buffer_load_dwordx4 v7, s[56:59], s63 offen offset:3072 sc1 lds
L_ca3:
    s_waitcnt vmcnt(13)
    s_barrier
    s_add_u32 m0, s60, 0
    s_nop 0
    buffer_load_dwordx4 v232, s[52:55], 0 offen lds
    v_add_u32 v232, 128, v232
    s_add_u32 m0, s60, 1024
    s_nop 0
    buffer_load_dwordx4 v233, s[52:55], 0 offen lds
    v_add_u32 v233, 128, v233
    s_add_u32 m0, s60, 2048
    s_nop 0
    buffer_load_dwordx4 v234, s[52:55], 0 offen lds
    v_add_u32 v234, 128, v234
    s_add_u32 m0, s60, 3072
    s_nop 0
    buffer_load_dwordx4 v235, s[52:55], 0 offen lds
    v_add_u32 v235, 128, v235
    s_add_u32 m0, s60, 4096
    s_nop 0
    buffer_load_dwordx4 v236, s[52:55], 0 offen lds
    v_add_u32 v236, 128, v236
L_ca3b:
    s_waitcnt vmcnt(5)
    s_barrier
    s_add_u32 m0, s60, 5120
    s_nop 0
    buffer_load_dwordx4 v232, s[52:55], 0 offen lds
    v_add_u32 v232, 128, v232
    s_add_u32 m0, s60, 6144
    s_nop 0
    buffer_load_dwordx4 v233, s[52:55], 0 offen lds
    v_add_u32 v233, 128, v233
    s_add_u32 m0, s60, 7168
    s_nop 0
    buffer_load_dwordx4 v234, s[52:55], 0 offen lds
    v_add_u32 v234, 128, v234
    s_add_u32 m0, s60, 8192
    s_nop 0
    buffer_load_dwordx4 v235, s[52:55], 0 offen lds
    v_add_u32 v235, 128, v235
    s_add_u32 m0, s60, 9216
    s_nop 0
    buffer_load_dwordx4 v236, s[52:55], 0 offen lds
    v_add_u32 v236, 128, v236
    s_waitcnt vmcnt(5)
    s_barrier
    s_add_u32 m0, s60, 10240
    s_nop 0
    buffer_load_dwordx4 v232, s[52:55], 0 offen lds
    v_add_u32 v232, 128, v232
    s_add_u32 m0, s60, 11264
    s_nop 0
    buffer_load_dwordx4 v233, s[52:55], 0 offen lds
    v_add_u32 v233, 128, v233
    s_add_u32 m0, s60, 12288
    s_nop 0
    buffer_load_dwordx4 v234, s[52:55], 0 offen lds
    v_add_u32 v234, 128, v234
    s_add_u32 m0, s60, 13312
    s_nop 0
    buffer_load_dwordx4 v235, s[52:55], 0 offen lds
    v_add_u32 v235, 128, v235
    s_add_u32 m0, s60, 14336
    s_nop 0
    buffer_load_dwordx4 v236, s[52:55], 0 offen lds
    v_add_u32 v236, 128, v236
    s_waitcnt vmcnt(5)
    s_barrier
    s_add_u32 m0, s60, 15360
    s_nop 0
    buffer_load_dwordx4 v232, s[52:55], 0 offen lds
    v_add_u32 v232, s32, v232
    s_add_u32 m0, s60, 16384
    s_nop 0
    buffer_load_dwordx4 v233, s[52:55], 0 offen lds
    v_add_u32 v233, s32, v233
    s_add_u32 m0, s60, 17408
    s_nop 0
    buffer_load_dwordx4 v234, s[52:55], 0 offen lds
    v_add_u32 v234, s32, v234
    s_add_u32 m0, s60, 18432
    s_nop 0
    buffer_load_dwordx4 v235, s[52:55], 0 offen lds
    v_add_u32 v235, s32, v235
    s_add_u32 m0, s60, 19456
    s_nop 0
    buffer_load_dwordx4 v236, s[52:55], 0 offen lds
    v_add_u32 v236, s32, v236
L_ca4:
    ds_read_b128 v[16:19], v10 offset:0
    ds_read_b128 v[20:23], v10 offset:4608
    ds_read_b128 v[24:27], v10 offset:9216
    ds_read_b128 v[28:31], v10 offset:13824
    v_add_u32 v10, 18432, v10
    s_mov_b32 s62, s70
    s_waitcnt lgkmcnt(0)
    v_mov_b32 v32, v16
    v_mov_b32 v33, v20
    v_mov_b32 v34, v24
    v_mov_b32 v35, v28
    buffer_store_dwordx4 v[32:35], v11, s[56:59], s62 offen sc1
    s_add_u32 s62, s62, 36864
    v_mov_b32 v36, v17
    v_mov_b32 v37, v21
    v_mov_b32 v38, v25
    v_mov_b32 v39, v29
    buffer_store_dwordx4 v[36:39], v11, s[56:59], s62 offen sc1
    s_add_u32 s62, s62, 258048
    v_mov_b32 v40, v18
    v_mov_b32 v41, v22
    v_mov_b32 v42, v26
    v_mov_b32 v43, v30
    buffer_store_dwordx4 v[40:43], v11, s[56:59], s62 offen sc1
    s_add_u32 s62, s62, 36864
    v_mov_b32 v44, v19
    v_mov_b32 v45, v23
    v_mov_b32 v46, v27
    v_mov_b32 v47, v31
    buffer_store_dwordx4 v[44:47], v11, s[56:59], s62 offen sc1
    s_add_u32 s62, s62, 258048
    s_add_u32 s70, s70, s71
    s_add_u32 s71, s32, 384
    s_lshr_b32 s71, s71, 6
    s_add_u32 s61, s61, 1
    s_cmp_lt_u32 s61, s17
    s_cbranch_scc1 L_ca2
    s_cmp_gt_u32 s61, s17
    s_cbranch_scc1 L_ca5
    s_waitcnt vmcnt(9)
    s_barrier
    v_mov_b32 v2, 0
L_caw:
    global_load_dword v3, v2, s[24:25] offset:128 sc1
    s_waitcnt vmcnt(0)
    v_cmp_ne_u32 s[64:65], 0, v3
    s_nop 0
    s_cmp_eq_u64 s[64:65], -1
    s_cbranch_scc1 L_cawd
    s_sleep 4
    s_sub_u32 s74, s74, 1
    s_cbranch_scc0 L_caw
    s_mov_b32 s74, 0
L_cawd:
    s_lshl_b32 s72, s30, 7
    s_add_u32 s72, s72, 2511360
    v_mov_b32 v3, 1
    s_barrier
    s_cmp_eq_u32 s29, 0
    s_cbranch_scc1 L_ca7
    s_cmp_lg_u32 s28, 4
    s_cbranch_scc1 L_ca7
    buffer_store_dword v3, v4, s[56:59], s72 offen sc1
    s_lshl_b32 s72, s33, 7
    s_add_u32 s72, s72, 2519552
L_ca7:
    s_barrier
    s_barrier
    s_branch L_ca4
L_ca5:
    s_waitcnt vmcnt(0)
    s_barrier
    s_cmp_lg_u32 s28, 4
    s_cbranch_scc1 L_ca6
    buffer_store_dword v3, v4, s[56:59], s72 offen sc1
L_ca6:
    s_branch L_early
.p2align 12
L_cmf:
L_cpad0:
    s_cbranch_vccnz L_cwret
    s_setprio 1
    ds_read_b64 v[16:17], v2 offset:0
    ds_read_b64 v[18:19], v2 offset:8
    ds_read_b128 v[80:83], v3 offset:3584
    ds_read_b64 v[20:21], v2 offset:160
    ds_read_b64 v[22:23], v2 offset:168
    ds_read_b128 v[84:87], v3 offset:3072
    ds_read_b64 v[24:25], v2 offset:1280
    ds_read_b64 v[26:27], v2 offset:1288
    ds_read_b128 v[88:91], v3 offset:2560
    ds_read_b64 v[28:29], v2 offset:1440
    ds_read_b64 v[30:31], v2 offset:1448
    ds_read_b128 v[92:95], v3 offset:2048
    ds_read_b64 v[32:33], v2 offset:2560
    ds_read_b64 v[34:35], v2 offset:2568
    ds_read_b128 v[96:99], v3 offset:1536
    ds_read_b64 v[36:37], v2 offset:2720
    ds_read_b64 v[38:39], v2 offset:2728
    ds_read_b128 v[100:103], v3 offset:1024
    ds_read_b64 v[40:41], v2 offset:3840
    ds_read_b64 v[42:43], v2 offset:3848
    ds_read_b128 v[104:107], v3 offset:512
    ds_read_b64 v[44:45], v2 offset:4000
    ds_read_b64 v[46:47], v2 offset:4008
    ds_read_b128 v[108:111], v3 offset:0
L_cm:
    s_waitcnt lgkmcnt(0)
    v_mfma_f32_16x16x32_bf16 v[144:147], v[80:83], v[12:15], 0
    v_and_or_b32 v16, v16, v240, v220
    v_mfma_f32_16x16x32_bf16 v[148:151], v[84:87], v[12:15], 0
    v_and_or_b32 v17, v17, v241, v221
    v_mfma_f32_16x16x32_bf16 v[152:155], v[88:91], v[12:15], 0
    v_and_or_b32 v18, v18, v242, v222
    v_mfma_f32_16x16x32_bf16 v[156:159], v[92:95], v[12:15], 0
    v_and_or_b32 v19, v19, v243, v223
    v_mfma_f32_16x16x32_bf16 v[160:163], v[96:99], v[12:15], 0
    v_mov_b32 v220, 0
    v_mfma_f32_16x16x32_bf16 v[164:167], v[100:103], v[12:15], 0
    v_mov_b32 v221, 0
    v_mfma_f32_16x16x32_bf16 v[168:171], v[104:107], v[12:15], 0
    v_mov_b32 v222, 0
    v_mfma_f32_16x16x32_bf16 v[172:175], v[108:111], v[12:15], 0
    v_mov_b32 v223, 0
    v_mfma_f32_16x16x32_bf16 v[144:147], v[80:83], v[16:19], v[144:147]
    ds_read_b64 v[48:49], v2 offset:64
    v_mfma_f32_16x16x32_bf16 v[148:151], v[84:87], v[16:19], v[148:151]
    ds_read_b64 v[50:51], v2 offset:72
    v_mfma_f32_16x16x32_bf16 v[152:155], v[88:91], v[16:19], v[152:155]
    ds_read_b128 v[112:115], v3 offset:3648
    v_mfma_f32_16x16x32_bf16 v[156:159], v[92:95], v[16:19], v[156:159]
    ds_read_b64 v[52:53], v2 offset:224
    v_mfma_f32_16x16x32_bf16 v[160:163], v[96:99], v[16:19], v[160:163]
    ds_read_b64 v[54:55], v2 offset:232
    v_mfma_f32_16x16x32_bf16 v[164:167], v[100:103], v[16:19], v[164:167]
    ds_read_b128 v[116:119], v3 offset:3136
    v_mfma_f32_16x16x32_bf16 v[168:171], v[104:107], v[16:19], v[168:171]
    ds_read_b64 v[56:57], v2 offset:1344
    v_mfma_f32_16x16x32_bf16 v[172:175], v[108:111], v[16:19], v[172:175]
    ds_read_b64 v[58:59], v2 offset:1352
    v_mfma_f32_16x16x32_bf16 v[148:151], v[80:83], v[20:23], v[148:151]
    ds_read_b128 v[120:123], v3 offset:2624
    v_mfma_f32_16x16x32_bf16 v[152:155], v[84:87], v[20:23], v[152:155]
    ds_read_b64 v[60:61], v2 offset:1504
    v_mfma_f32_16x16x32_bf16 v[156:159], v[88:91], v[20:23], v[156:159]
    ds_read_b64 v[62:63], v2 offset:1512
    v_mfma_f32_16x16x32_bf16 v[160:163], v[92:95], v[20:23], v[160:163]
    ds_read_b128 v[124:127], v3 offset:2112
    v_mfma_f32_16x16x32_bf16 v[164:167], v[96:99], v[20:23], v[164:167]
    ds_read_b64 v[64:65], v2 offset:2624
    v_mfma_f32_16x16x32_bf16 v[168:171], v[100:103], v[20:23], v[168:171]
    ds_read_b64 v[66:67], v2 offset:2632
    v_mfma_f32_16x16x32_bf16 v[172:175], v[104:107], v[20:23], v[172:175]
    ds_read_b128 v[128:131], v3 offset:1600
    v_mfma_f32_16x16x32_bf16 v[152:155], v[80:83], v[24:27], v[152:155]
    ds_read_b64 v[68:69], v2 offset:2784
    v_mfma_f32_16x16x32_bf16 v[156:159], v[84:87], v[24:27], v[156:159]
    ds_read_b64 v[70:71], v2 offset:2792
    v_mfma_f32_16x16x32_bf16 v[160:163], v[88:91], v[24:27], v[160:163]
    ds_read_b128 v[132:135], v3 offset:1088
    v_mfma_f32_16x16x32_bf16 v[164:167], v[92:95], v[24:27], v[164:167]
    ds_read_b64 v[72:73], v2 offset:3904
    v_mfma_f32_16x16x32_bf16 v[168:171], v[96:99], v[24:27], v[168:171]
    ds_read_b64 v[74:75], v2 offset:3912
    v_mfma_f32_16x16x32_bf16 v[172:175], v[100:103], v[24:27], v[172:175]
    ds_read_b128 v[136:139], v3 offset:576
    v_mfma_f32_16x16x32_bf16 v[156:159], v[80:83], v[28:31], v[156:159]
    ds_read_b64 v[76:77], v2 offset:4064
    v_mfma_f32_16x16x32_bf16 v[160:163], v[84:87], v[28:31], v[160:163]
    ds_read_b64 v[78:79], v2 offset:4072
    v_mfma_f32_16x16x32_bf16 v[164:167], v[88:91], v[28:31], v[164:167]
    ds_read_b128 v[140:143], v3 offset:64
    v_mfma_f32_16x16x32_bf16 v[168:171], v[92:95], v[28:31], v[168:171]
    v_mfma_f32_16x16x32_bf16 v[172:175], v[96:99], v[28:31], v[172:175]
    v_mfma_f32_16x16x32_bf16 v[160:163], v[80:83], v[32:35], v[160:163]
    v_mfma_f32_16x16x32_bf16 v[164:167], v[84:87], v[32:35], v[164:167]
    v_mfma_f32_16x16x32_bf16 v[168:171], v[88:91], v[32:35], v[168:171]
    v_mfma_f32_16x16x32_bf16 v[172:175], v[92:95], v[32:35], v[172:175]
    v_mfma_f32_16x16x32_bf16 v[164:167], v[80:83], v[36:39], v[164:167]
    v_mfma_f32_16x16x32_bf16 v[168:171], v[84:87], v[36:39], v[168:171]
    v_mfma_f32_16x16x32_bf16 v[172:175], v[88:91], v[36:39], v[172:175]
    v_mfma_f32_16x16x32_bf16 v[168:171], v[80:83], v[40:43], v[168:171]
    v_mfma_f32_16x16x32_bf16 v[172:175], v[84:87], v[40:43], v[172:175]
    v_mfma_f32_16x16x32_bf16 v[172:175], v[80:83], v[44:47], v[172:175]
    s_waitcnt lgkmcnt(0)
    s_barrier
    v_mfma_f32_16x16x32_bf16 v[144:147], v[112:115], v[48:51], v[144:147]
    ds_read_b64 v[16:17], v2 offset:5120
    v_mfma_f32_16x16x32_bf16 v[148:151], v[116:119], v[48:51], v[148:151]
    ds_read_b64 v[18:19], v2 offset:5128
    v_mfma_f32_16x16x32_bf16 v[152:155], v[120:123], v[48:51], v[152:155]
    ds_read_b128 v[80:83], v3 offset:3712
    v_mfma_f32_16x16x32_bf16 v[156:159], v[124:127], v[48:51], v[156:159]
    ds_read_b64 v[20:21], v2 offset:5280
    v_mfma_f32_16x16x32_bf16 v[160:163], v[128:131], v[48:51], v[160:163]
    ds_read_b64 v[22:23], v2 offset:5288
    v_mfma_f32_16x16x32_bf16 v[164:167], v[132:135], v[48:51], v[164:167]
    ds_read_b128 v[84:87], v3 offset:3200
    v_mfma_f32_16x16x32_bf16 v[168:171], v[136:139], v[48:51], v[168:171]
    ds_read_b64 v[24:25], v2 offset:6400
    v_mfma_f32_16x16x32_bf16 v[172:175], v[140:143], v[48:51], v[172:175]
    ds_read_b64 v[26:27], v2 offset:6408
    v_mfma_f32_16x16x32_bf16 v[148:151], v[112:115], v[52:55], v[148:151]
    ds_read_b128 v[88:91], v3 offset:2688
    v_mfma_f32_16x16x32_bf16 v[152:155], v[116:119], v[52:55], v[152:155]
    ds_read_b64 v[28:29], v2 offset:6560
    v_mfma_f32_16x16x32_bf16 v[156:159], v[120:123], v[52:55], v[156:159]
    ds_read_b64 v[30:31], v2 offset:6568
    v_mfma_f32_16x16x32_bf16 v[160:163], v[124:127], v[52:55], v[160:163]
    ds_read_b128 v[92:95], v3 offset:2176
    v_mfma_f32_16x16x32_bf16 v[164:167], v[128:131], v[52:55], v[164:167]
    ds_read_b64 v[32:33], v2 offset:7680
    v_mfma_f32_16x16x32_bf16 v[168:171], v[132:135], v[52:55], v[168:171]
    ds_read_b64 v[34:35], v2 offset:7688
    v_mfma_f32_16x16x32_bf16 v[172:175], v[136:139], v[52:55], v[172:175]
    ds_read_b128 v[96:99], v3 offset:1664
    v_mfma_f32_16x16x32_bf16 v[152:155], v[112:115], v[56:59], v[152:155]
    ds_read_b64 v[36:37], v2 offset:7840
    v_mfma_f32_16x16x32_bf16 v[156:159], v[116:119], v[56:59], v[156:159]
    ds_read_b64 v[38:39], v2 offset:7848
    v_mfma_f32_16x16x32_bf16 v[160:163], v[120:123], v[56:59], v[160:163]
    ds_read_b128 v[100:103], v3 offset:1152
    v_mfma_f32_16x16x32_bf16 v[164:167], v[124:127], v[56:59], v[164:167]
    ds_read_b64 v[40:41], v2 offset:8960
    v_mfma_f32_16x16x32_bf16 v[168:171], v[128:131], v[56:59], v[168:171]
    ds_read_b64 v[42:43], v2 offset:8968
    v_mfma_f32_16x16x32_bf16 v[172:175], v[132:135], v[56:59], v[172:175]
    ds_read_b128 v[104:107], v3 offset:640
    v_mfma_f32_16x16x32_bf16 v[156:159], v[112:115], v[60:63], v[156:159]
    ds_read_b64 v[44:45], v2 offset:9120
    v_mfma_f32_16x16x32_bf16 v[160:163], v[116:119], v[60:63], v[160:163]
    ds_read_b64 v[46:47], v2 offset:9128
    v_mfma_f32_16x16x32_bf16 v[164:167], v[120:123], v[60:63], v[164:167]
    ds_read_b128 v[108:111], v3 offset:128
    v_mfma_f32_16x16x32_bf16 v[168:171], v[124:127], v[60:63], v[168:171]
    s_pack_ll_b32_b16 s62, s44, s44
    v_mfma_f32_16x16x32_bf16 v[172:175], v[128:131], v[60:63], v[172:175]
    v_and_b32 v12, s62, v244
    v_mfma_f32_16x16x32_bf16 v[160:163], v[112:115], v[64:67], v[160:163]
    v_and_b32 v13, s62, v245
    v_mfma_f32_16x16x32_bf16 v[164:167], v[116:119], v[64:67], v[164:167]
    v_and_b32 v14, s62, v246
    v_mfma_f32_16x16x32_bf16 v[168:171], v[120:123], v[64:67], v[168:171]
    v_and_b32 v15, s62, v247
    v_mfma_f32_16x16x32_bf16 v[172:175], v[124:127], v[64:67], v[172:175]
    s_mov_b32 s44, s45
    v_mfma_f32_16x16x32_bf16 v[164:167], v[112:115], v[68:71], v[164:167]
    s_mov_b32 s45, s46
    v_mfma_f32_16x16x32_bf16 v[168:171], v[116:119], v[68:71], v[168:171]
    v_mfma_f32_16x16x32_bf16 v[172:175], v[120:123], v[68:71], v[172:175]
    v_mfma_f32_16x16x32_bf16 v[168:171], v[112:115], v[72:75], v[168:171]
    v_mfma_f32_16x16x32_bf16 v[172:175], v[116:119], v[72:75], v[172:175]
    v_mfma_f32_16x16x32_bf16 v[172:175], v[112:115], v[76:79], v[172:175]
    s_waitcnt lgkmcnt(0)
    v_mfma_f32_16x16x32_bf16 v[144:147], v[80:83], v[16:19], v[144:147]
    ds_read_b64 v[48:49], v2 offset:5184
    v_mfma_f32_16x16x32_bf16 v[148:151], v[84:87], v[16:19], v[148:151]
    ds_read_b64 v[50:51], v2 offset:5192
    v_mfma_f32_16x16x32_bf16 v[152:155], v[88:91], v[16:19], v[152:155]
    ds_read_b128 v[112:115], v3 offset:3776
    v_mfma_f32_16x16x32_bf16 v[156:159], v[92:95], v[16:19], v[156:159]
    ds_read_b64 v[52:53], v2 offset:5344
    v_mfma_f32_16x16x32_bf16 v[160:163], v[96:99], v[16:19], v[160:163]
    ds_read_b64 v[54:55], v2 offset:5352
    v_mfma_f32_16x16x32_bf16 v[164:167], v[100:103], v[16:19], v[164:167]
    ds_read_b128 v[116:119], v3 offset:3264
    v_mfma_f32_16x16x32_bf16 v[168:171], v[104:107], v[16:19], v[168:171]
    ds_read_b64 v[56:57], v2 offset:6464
    v_mfma_f32_16x16x32_bf16 v[172:175], v[108:111], v[16:19], v[172:175]
    ds_read_b64 v[58:59], v2 offset:6472
    v_mfma_f32_16x16x32_bf16 v[148:151], v[80:83], v[20:23], v[148:151]
    ds_read_b128 v[120:123], v3 offset:2752
    v_mfma_f32_16x16x32_bf16 v[152:155], v[84:87], v[20:23], v[152:155]
    ds_read_b64 v[60:61], v2 offset:6624
    v_mfma_f32_16x16x32_bf16 v[156:159], v[88:91], v[20:23], v[156:159]
    ds_read_b64 v[62:63], v2 offset:6632
    v_mfma_f32_16x16x32_bf16 v[160:163], v[92:95], v[20:23], v[160:163]
    ds_read_b128 v[124:127], v3 offset:2240
    v_mfma_f32_16x16x32_bf16 v[164:167], v[96:99], v[20:23], v[164:167]
    ds_read_b64 v[64:65], v2 offset:7744
    v_mfma_f32_16x16x32_bf16 v[168:171], v[100:103], v[20:23], v[168:171]
    ds_read_b64 v[66:67], v2 offset:7752
    v_mfma_f32_16x16x32_bf16 v[172:175], v[104:107], v[20:23], v[172:175]
    ds_read_b128 v[128:131], v3 offset:1728
    v_mfma_f32_16x16x32_bf16 v[152:155], v[80:83], v[24:27], v[152:155]
    ds_read_b64 v[68:69], v2 offset:7904
    v_mfma_f32_16x16x32_bf16 v[156:159], v[84:87], v[24:27], v[156:159]
    ds_read_b64 v[70:71], v2 offset:7912
    v_mfma_f32_16x16x32_bf16 v[160:163], v[88:91], v[24:27], v[160:163]
    ds_read_b128 v[132:135], v3 offset:1216
    v_mfma_f32_16x16x32_bf16 v[164:167], v[92:95], v[24:27], v[164:167]
    ds_read_b64 v[72:73], v2 offset:9024
    v_mfma_f32_16x16x32_bf16 v[168:171], v[96:99], v[24:27], v[168:171]
    ds_read_b64 v[74:75], v2 offset:9032
    v_mfma_f32_16x16x32_bf16 v[172:175], v[100:103], v[24:27], v[172:175]
    ds_read_b128 v[136:139], v3 offset:704
    v_mfma_f32_16x16x32_bf16 v[156:159], v[80:83], v[28:31], v[156:159]
    ds_read_b64 v[76:77], v2 offset:9184
    v_mfma_f32_16x16x32_bf16 v[160:163], v[84:87], v[28:31], v[160:163]
    ds_read_b64 v[78:79], v2 offset:9192
    v_mfma_f32_16x16x32_bf16 v[164:167], v[88:91], v[28:31], v[164:167]
    ds_read_b128 v[140:143], v3 offset:192
    v_mfma_f32_16x16x32_bf16 v[168:171], v[92:95], v[28:31], v[168:171]
    v_mfma_f32_16x16x32_bf16 v[172:175], v[96:99], v[28:31], v[172:175]
    v_mfma_f32_16x16x32_bf16 v[160:163], v[80:83], v[32:35], v[160:163]
    v_mfma_f32_16x16x32_bf16 v[164:167], v[84:87], v[32:35], v[164:167]
    v_mfma_f32_16x16x32_bf16 v[168:171], v[88:91], v[32:35], v[168:171]
    v_mfma_f32_16x16x32_bf16 v[172:175], v[92:95], v[32:35], v[172:175]
    v_mfma_f32_16x16x32_bf16 v[164:167], v[80:83], v[36:39], v[164:167]
    v_mfma_f32_16x16x32_bf16 v[168:171], v[84:87], v[36:39], v[168:171]
    v_mfma_f32_16x16x32_bf16 v[172:175], v[88:91], v[36:39], v[172:175]
    v_mfma_f32_16x16x32_bf16 v[168:171], v[80:83], v[40:43], v[168:171]
    v_mfma_f32_16x16x32_bf16 v[172:175], v[84:87], v[40:43], v[172:175]
    v_mfma_f32_16x16x32_bf16 v[172:175], v[80:83], v[44:47], v[172:175]
    s_waitcnt lgkmcnt(0)
    s_barrier
    v_mfma_f32_16x16x32_bf16 v[144:147], v[112:115], v[48:51], v[144:147]
    ds_read_b64 v[16:17], v2 offset:10240
    v_mfma_f32_16x16x32_bf16 v[148:151], v[116:119], v[48:51], v[148:151]
    ds_read_b64 v[18:19], v2 offset:10248
    v_mfma_f32_16x16x32_bf16 v[152:155], v[120:123], v[48:51], v[152:155]
    ds_read_b128 v[80:83], v3 offset:3840
    v_mfma_f32_16x16x32_bf16 v[156:159], v[124:127], v[48:51], v[156:159]
    ds_read_b64 v[20:21], v2 offset:10400
    v_mfma_f32_16x16x32_bf16 v[160:163], v[128:131], v[48:51], v[160:163]
    ds_read_b64 v[22:23], v2 offset:10408
    v_mfma_f32_16x16x32_bf16 v[164:167], v[132:135], v[48:51], v[164:167]
    ds_read_b128 v[84:87], v3 offset:3328
    v_mfma_f32_16x16x32_bf16 v[168:171], v[136:139], v[48:51], v[168:171]
    ds_read_b64 v[24:25], v2 offset:11520
    v_mfma_f32_16x16x32_bf16 v[172:175], v[140:143], v[48:51], v[172:175]
    ds_read_b64 v[26:27], v2 offset:11528
    v_mfma_f32_16x16x32_bf16 v[148:151], v[112:115], v[52:55], v[148:151]
    ds_read_b128 v[88:91], v3 offset:2816
    v_mfma_f32_16x16x32_bf16 v[152:155], v[116:119], v[52:55], v[152:155]
    ds_read_b64 v[28:29], v2 offset:11680
    v_mfma_f32_16x16x32_bf16 v[156:159], v[120:123], v[52:55], v[156:159]
    ds_read_b64 v[30:31], v2 offset:11688
    v_mfma_f32_16x16x32_bf16 v[160:163], v[124:127], v[52:55], v[160:163]
    ds_read_b128 v[92:95], v3 offset:2304
    v_mfma_f32_16x16x32_bf16 v[164:167], v[128:131], v[52:55], v[164:167]
    ds_read_b64 v[32:33], v2 offset:12800
    v_mfma_f32_16x16x32_bf16 v[168:171], v[132:135], v[52:55], v[168:171]
    ds_read_b64 v[34:35], v2 offset:12808
    v_mfma_f32_16x16x32_bf16 v[172:175], v[136:139], v[52:55], v[172:175]
    ds_read_b128 v[96:99], v3 offset:1792
    v_mfma_f32_16x16x32_bf16 v[152:155], v[112:115], v[56:59], v[152:155]
    ds_read_b64 v[36:37], v2 offset:12960
    v_mfma_f32_16x16x32_bf16 v[156:159], v[116:119], v[56:59], v[156:159]
    ds_read_b64 v[38:39], v2 offset:12968
    v_mfma_f32_16x16x32_bf16 v[160:163], v[120:123], v[56:59], v[160:163]
    ds_read_b128 v[100:103], v3 offset:1280
    v_mfma_f32_16x16x32_bf16 v[164:167], v[124:127], v[56:59], v[164:167]
    ds_read_b64 v[40:41], v2 offset:14080
    v_mfma_f32_16x16x32_bf16 v[168:171], v[128:131], v[56:59], v[168:171]
    ds_read_b64 v[42:43], v2 offset:14088
    v_mfma_f32_16x16x32_bf16 v[172:175], v[132:135], v[56:59], v[172:175]
    ds_read_b128 v[104:107], v3 offset:768
    v_mfma_f32_16x16x32_bf16 v[156:159], v[112:115], v[60:63], v[156:159]
    ds_read_b64 v[44:45], v2 offset:14240
    v_mfma_f32_16x16x32_bf16 v[160:163], v[116:119], v[60:63], v[160:163]
    ds_read_b64 v[46:47], v2 offset:14248
    v_mfma_f32_16x16x32_bf16 v[164:167], v[120:123], v[60:63], v[164:167]
    ds_read_b128 v[108:111], v3 offset:256
    v_mfma_f32_16x16x32_bf16 v[168:171], v[124:127], v[60:63], v[168:171]
    v_mfma_f32_16x16x32_bf16 v[172:175], v[128:131], v[60:63], v[172:175]
    v_mfma_f32_16x16x32_bf16 v[160:163], v[112:115], v[64:67], v[160:163]
    v_mfma_f32_16x16x32_bf16 v[164:167], v[116:119], v[64:67], v[164:167]
    v_mfma_f32_16x16x32_bf16 v[168:171], v[120:123], v[64:67], v[168:171]
    v_mfma_f32_16x16x32_bf16 v[172:175], v[124:127], v[64:67], v[172:175]
    v_mfma_f32_16x16x32_bf16 v[164:167], v[112:115], v[68:71], v[164:167]
    v_mfma_f32_16x16x32_bf16 v[168:171], v[116:119], v[68:71], v[168:171]
    v_mfma_f32_16x16x32_bf16 v[172:175], v[120:123], v[68:71], v[172:175]
    v_mfma_f32_16x16x32_bf16 v[168:171], v[112:115], v[72:75], v[168:171]
    v_mfma_f32_16x16x32_bf16 v[172:175], v[116:119], v[72:75], v[172:175]
    v_mfma_f32_16x16x32_bf16 v[172:175], v[112:115], v[76:79], v[172:175]
    s_waitcnt lgkmcnt(0)
    v_mfma_f32_16x16x32_bf16 v[144:147], v[80:83], v[16:19], v[144:147]
    ds_read_b64 v[48:49], v2 offset:10304
    v_mfma_f32_16x16x32_bf16 v[148:151], v[84:87], v[16:19], v[148:151]
    ds_read_b64 v[50:51], v2 offset:10312
    v_mfma_f32_16x16x32_bf16 v[152:155], v[88:91], v[16:19], v[152:155]
    ds_read_b128 v[112:115], v3 offset:3904
    v_mfma_f32_16x16x32_bf16 v[156:159], v[92:95], v[16:19], v[156:159]
    ds_read_b64 v[52:53], v2 offset:10464
    v_mfma_f32_16x16x32_bf16 v[160:163], v[96:99], v[16:19], v[160:163]
    ds_read_b64 v[54:55], v2 offset:10472
    v_mfma_f32_16x16x32_bf16 v[164:167], v[100:103], v[16:19], v[164:167]
    ds_read_b128 v[116:119], v3 offset:3392
    v_mfma_f32_16x16x32_bf16 v[168:171], v[104:107], v[16:19], v[168:171]
    ds_read_b64 v[56:57], v2 offset:11584
    v_mfma_f32_16x16x32_bf16 v[172:175], v[108:111], v[16:19], v[172:175]
    ds_read_b64 v[58:59], v2 offset:11592
    v_mfma_f32_16x16x32_bf16 v[148:151], v[80:83], v[20:23], v[148:151]
    ds_read_b128 v[120:123], v3 offset:2880
    v_mfma_f32_16x16x32_bf16 v[152:155], v[84:87], v[20:23], v[152:155]
    ds_read_b64 v[60:61], v2 offset:11744
    v_mfma_f32_16x16x32_bf16 v[156:159], v[88:91], v[20:23], v[156:159]
    ds_read_b64 v[62:63], v2 offset:11752
    v_mfma_f32_16x16x32_bf16 v[160:163], v[92:95], v[20:23], v[160:163]
    ds_read_b128 v[124:127], v3 offset:2368
    v_mfma_f32_16x16x32_bf16 v[164:167], v[96:99], v[20:23], v[164:167]
    ds_read_b64 v[64:65], v2 offset:12864
    v_mfma_f32_16x16x32_bf16 v[168:171], v[100:103], v[20:23], v[168:171]
    ds_read_b64 v[66:67], v2 offset:12872
    v_mfma_f32_16x16x32_bf16 v[172:175], v[104:107], v[20:23], v[172:175]
    ds_read_b128 v[128:131], v3 offset:1856
    v_mfma_f32_16x16x32_bf16 v[152:155], v[80:83], v[24:27], v[152:155]
    ds_read_b64 v[68:69], v2 offset:13024
    v_mfma_f32_16x16x32_bf16 v[156:159], v[84:87], v[24:27], v[156:159]
    ds_read_b64 v[70:71], v2 offset:13032
    v_mfma_f32_16x16x32_bf16 v[160:163], v[88:91], v[24:27], v[160:163]
    ds_read_b128 v[132:135], v3 offset:1344
    v_mfma_f32_16x16x32_bf16 v[164:167], v[92:95], v[24:27], v[164:167]
    ds_read_b64 v[72:73], v2 offset:14144
    v_mfma_f32_16x16x32_bf16 v[168:171], v[96:99], v[24:27], v[168:171]
    ds_read_b64 v[74:75], v2 offset:14152
    v_mfma_f32_16x16x32_bf16 v[172:175], v[100:103], v[24:27], v[172:175]
    ds_read_b128 v[136:139], v3 offset:832
    v_mfma_f32_16x16x32_bf16 v[156:159], v[80:83], v[28:31], v[156:159]
    ds_read_b64 v[76:77], v2 offset:14304
    v_mfma_f32_16x16x32_bf16 v[160:163], v[84:87], v[28:31], v[160:163]
    ds_read_b64 v[78:79], v2 offset:14312
    v_mfma_f32_16x16x32_bf16 v[164:167], v[88:91], v[28:31], v[164:167]
    ds_read_b128 v[140:143], v3 offset:320
    v_mfma_f32_16x16x32_bf16 v[168:171], v[92:95], v[28:31], v[168:171]
    v_mfma_f32_16x16x32_bf16 v[172:175], v[96:99], v[28:31], v[172:175]
    v_mfma_f32_16x16x32_bf16 v[160:163], v[80:83], v[32:35], v[160:163]
    v_mfma_f32_16x16x32_bf16 v[164:167], v[84:87], v[32:35], v[164:167]
    v_mfma_f32_16x16x32_bf16 v[168:171], v[88:91], v[32:35], v[168:171]
    v_mfma_f32_16x16x32_bf16 v[172:175], v[92:95], v[32:35], v[172:175]
    v_mfma_f32_16x16x32_bf16 v[164:167], v[80:83], v[36:39], v[164:167]
    v_mfma_f32_16x16x32_bf16 v[168:171], v[84:87], v[36:39], v[168:171]
    v_mfma_f32_16x16x32_bf16 v[172:175], v[88:91], v[36:39], v[172:175]
    v_mfma_f32_16x16x32_bf16 v[168:171], v[80:83], v[40:43], v[168:171]
    v_mfma_f32_16x16x32_bf16 v[172:175], v[84:87], v[40:43], v[172:175]
    v_mfma_f32_16x16x32_bf16 v[172:175], v[80:83], v[44:47], v[172:175]
    s_waitcnt lgkmcnt(0)
    s_barrier
    v_mfma_f32_16x16x32_bf16 v[144:147], v[112:115], v[48:51], v[144:147]
    ds_read_b64 v[16:17], v2 offset:15360
    v_mfma_f32_16x16x32_bf16 v[148:151], v[116:119], v[48:51], v[148:151]
    ds_read_b64 v[18:19], v2 offset:15368
    v_mfma_f32_16x16x32_bf16 v[152:155], v[120:123], v[48:51], v[152:155]
    ds_read_b128 v[80:83], v3 offset:3968
    v_mfma_f32_16x16x32_bf16 v[156:159], v[124:127], v[48:51], v[156:159]
    ds_read_b64 v[20:21], v2 offset:15520
    v_mfma_f32_16x16x32_bf16 v[160:163], v[128:131], v[48:51], v[160:163]
    ds_read_b64 v[22:23], v2 offset:15528
    v_mfma_f32_16x16x32_bf16 v[164:167], v[132:135], v[48:51], v[164:167]
    ds_read_b128 v[84:87], v3 offset:3456
    v_mfma_f32_16x16x32_bf16 v[168:171], v[136:139], v[48:51], v[168:171]
    ds_read_b64 v[24:25], v2 offset:16640
    v_mfma_f32_16x16x32_bf16 v[172:175], v[140:143], v[48:51], v[172:175]
    ds_read_b64 v[26:27], v2 offset:16648
    v_mfma_f32_16x16x32_bf16 v[148:151], v[112:115], v[52:55], v[148:151]
    ds_read_b128 v[88:91], v3 offset:2944
    v_mfma_f32_16x16x32_bf16 v[152:155], v[116:119], v[52:55], v[152:155]
    ds_read_b64 v[28:29], v2 offset:16800
    v_mfma_f32_16x16x32_bf16 v[156:159], v[120:123], v[52:55], v[156:159]
    ds_read_b64 v[30:31], v2 offset:16808
    v_mfma_f32_16x16x32_bf16 v[160:163], v[124:127], v[52:55], v[160:163]
    ds_read_b128 v[92:95], v3 offset:2432
    v_mfma_f32_16x16x32_bf16 v[164:167], v[128:131], v[52:55], v[164:167]
    ds_read_b64 v[32:33], v2 offset:17920
    v_mfma_f32_16x16x32_bf16 v[168:171], v[132:135], v[52:55], v[168:171]
    ds_read_b64 v[34:35], v2 offset:17928
    v_mfma_f32_16x16x32_bf16 v[172:175], v[136:139], v[52:55], v[172:175]
    ds_read_b128 v[96:99], v3 offset:1920
    v_mfma_f32_16x16x32_bf16 v[152:155], v[112:115], v[56:59], v[152:155]
    ds_read_b64 v[36:37], v2 offset:18080
    v_mfma_f32_16x16x32_bf16 v[156:159], v[116:119], v[56:59], v[156:159]
    ds_read_b64 v[38:39], v2 offset:18088
    v_mfma_f32_16x16x32_bf16 v[160:163], v[120:123], v[56:59], v[160:163]
    ds_read_b128 v[100:103], v3 offset:1408
    v_mfma_f32_16x16x32_bf16 v[164:167], v[124:127], v[56:59], v[164:167]
    ds_read_b64 v[40:41], v2 offset:19200
    v_mfma_f32_16x16x32_bf16 v[168:171], v[128:131], v[56:59], v[168:171]
    ds_read_b64 v[42:43], v2 offset:19208
    v_mfma_f32_16x16x32_bf16 v[172:175], v[132:135], v[56:59], v[172:175]
    ds_read_b128 v[104:107], v3 offset:896
    v_mfma_f32_16x16x32_bf16 v[156:159], v[112:115], v[60:63], v[156:159]
    ds_read_b64 v[44:45], v2 offset:19360
    v_mfma_f32_16x16x32_bf16 v[160:163], v[116:119], v[60:63], v[160:163]
    ds_read_b64 v[46:47], v2 offset:19368
    v_mfma_f32_16x16x32_bf16 v[164:167], v[120:123], v[60:63], v[164:167]
    ds_read_b128 v[108:111], v3 offset:384
    v_mfma_f32_16x16x32_bf16 v[168:171], v[124:127], v[60:63], v[168:171]
    v_mfma_f32_16x16x32_bf16 v[172:175], v[128:131], v[60:63], v[172:175]
    v_mfma_f32_16x16x32_bf16 v[160:163], v[112:115], v[64:67], v[160:163]
    v_mfma_f32_16x16x32_bf16 v[164:167], v[116:119], v[64:67], v[164:167]
    v_mfma_f32_16x16x32_bf16 v[168:171], v[120:123], v[64:67], v[168:171]
    v_mfma_f32_16x16x32_bf16 v[172:175], v[124:127], v[64:67], v[172:175]
    v_mfma_f32_16x16x32_bf16 v[164:167], v[112:115], v[68:71], v[164:167]
    v_mfma_f32_16x16x32_bf16 v[168:171], v[116:119], v[68:71], v[168:171]
    v_mfma_f32_16x16x32_bf16 v[172:175], v[120:123], v[68:71], v[172:175]
    v_mfma_f32_16x16x32_bf16 v[168:171], v[112:115], v[72:75], v[168:171]
    v_mfma_f32_16x16x32_bf16 v[172:175], v[116:119], v[72:75], v[172:175]
    v_mfma_f32_16x16x32_bf16 v[172:175], v[112:115], v[76:79], v[172:175]
    s_waitcnt lgkmcnt(0)
    v_mfma_f32_16x16x32_bf16 v[144:147], v[80:83], v[16:19], v[144:147]
    ds_read_b64 v[48:49], v2 offset:15424
    v_mfma_f32_16x16x32_bf16 v[148:151], v[84:87], v[16:19], v[148:151]
    ds_read_b64 v[50:51], v2 offset:15432
    v_mfma_f32_16x16x32_bf16 v[152:155], v[88:91], v[16:19], v[152:155]
    ds_read_b128 v[112:115], v3 offset:4032
    v_mfma_f32_16x16x32_bf16 v[156:159], v[92:95], v[16:19], v[156:159]
    ds_read_b64 v[52:53], v2 offset:15584
    v_mfma_f32_16x16x32_bf16 v[160:163], v[96:99], v[16:19], v[160:163]
    ds_read_b64 v[54:55], v2 offset:15592
    v_mfma_f32_16x16x32_bf16 v[164:167], v[100:103], v[16:19], v[164:167]
    ds_read_b128 v[116:119], v3 offset:3520
    v_mfma_f32_16x16x32_bf16 v[168:171], v[104:107], v[16:19], v[168:171]
    ds_read_b64 v[56:57], v2 offset:16704
    v_mfma_f32_16x16x32_bf16 v[172:175], v[108:111], v[16:19], v[172:175]
    ds_read_b64 v[58:59], v2 offset:16712
    v_mfma_f32_16x16x32_bf16 v[148:151], v[80:83], v[20:23], v[148:151]
    ds_read_b128 v[120:123], v3 offset:3008
    v_mfma_f32_16x16x32_bf16 v[152:155], v[84:87], v[20:23], v[152:155]
    ds_read_b64 v[60:61], v2 offset:16864
    v_mfma_f32_16x16x32_bf16 v[156:159], v[88:91], v[20:23], v[156:159]
    ds_read_b64 v[62:63], v2 offset:16872
    v_mfma_f32_16x16x32_bf16 v[160:163], v[92:95], v[20:23], v[160:163]
    ds_read_b128 v[124:127], v3 offset:2496
    v_mfma_f32_16x16x32_bf16 v[164:167], v[96:99], v[20:23], v[164:167]
    ds_read_b64 v[64:65], v2 offset:17984
    v_mfma_f32_16x16x32_bf16 v[168:171], v[100:103], v[20:23], v[168:171]
    ds_read_b64 v[66:67], v2 offset:17992
    v_mfma_f32_16x16x32_bf16 v[172:175], v[104:107], v[20:23], v[172:175]
    ds_read_b128 v[128:131], v3 offset:1984
    v_mfma_f32_16x16x32_bf16 v[152:155], v[80:83], v[24:27], v[152:155]
    ds_read_b64 v[68:69], v2 offset:18144
    v_mfma_f32_16x16x32_bf16 v[156:159], v[84:87], v[24:27], v[156:159]
    ds_read_b64 v[70:71], v2 offset:18152
    v_mfma_f32_16x16x32_bf16 v[160:163], v[88:91], v[24:27], v[160:163]
    ds_read_b128 v[132:135], v3 offset:1472
    v_mfma_f32_16x16x32_bf16 v[164:167], v[92:95], v[24:27], v[164:167]
    ds_read_b64 v[72:73], v2 offset:19264
    v_mfma_f32_16x16x32_bf16 v[168:171], v[96:99], v[24:27], v[168:171]
    ds_read_b64 v[74:75], v2 offset:19272
    v_mfma_f32_16x16x32_bf16 v[172:175], v[100:103], v[24:27], v[172:175]
    ds_read_b128 v[136:139], v3 offset:960
    v_mfma_f32_16x16x32_bf16 v[156:159], v[80:83], v[28:31], v[156:159]
    ds_read_b64 v[76:77], v2 offset:19424
    v_mfma_f32_16x16x32_bf16 v[160:163], v[84:87], v[28:31], v[160:163]
    ds_read_b64 v[78:79], v2 offset:19432
    v_mfma_f32_16x16x32_bf16 v[164:167], v[88:91], v[28:31], v[164:167]
    ds_read_b128 v[140:143], v3 offset:448
    v_mfma_f32_16x16x32_bf16 v[168:171], v[92:95], v[28:31], v[168:171]
    v_mfma_f32_16x16x32_bf16 v[172:175], v[96:99], v[28:31], v[172:175]
    v_mfma_f32_16x16x32_bf16 v[160:163], v[80:83], v[32:35], v[160:163]
    v_mfma_f32_16x16x32_bf16 v[164:167], v[84:87], v[32:35], v[164:167]
    v_mfma_f32_16x16x32_bf16 v[168:171], v[88:91], v[32:35], v[168:171]
    v_mfma_f32_16x16x32_bf16 v[172:175], v[92:95], v[32:35], v[172:175]
    v_mfma_f32_16x16x32_bf16 v[164:167], v[80:83], v[36:39], v[164:167]
    v_mfma_f32_16x16x32_bf16 v[168:171], v[84:87], v[36:39], v[168:171]
    v_mfma_f32_16x16x32_bf16 v[172:175], v[88:91], v[36:39], v[172:175]
    v_mfma_f32_16x16x32_bf16 v[168:171], v[80:83], v[40:43], v[168:171]
    v_mfma_f32_16x16x32_bf16 v[172:175], v[84:87], v[40:43], v[172:175]
    v_mfma_f32_16x16x32_bf16 v[172:175], v[80:83], v[44:47], v[172:175]
    s_waitcnt lgkmcnt(0)
    s_barrier
    v_mfma_f32_16x16x32_bf16 v[144:147], v[112:115], v[48:51], v[144:147]
    ds_read_b64 v[16:17], v2 offset:0
    v_mfma_f32_16x16x32_bf16 v[148:151], v[116:119], v[48:51], v[148:151]
    ds_read_b64 v[18:19], v2 offset:8
    v_mfma_f32_16x16x32_bf16 v[152:155], v[120:123], v[48:51], v[152:155]
    ds_read_b128 v[80:83], v3 offset:22016
    v_mfma_f32_16x16x32_bf16 v[156:159], v[124:127], v[48:51], v[156:159]
    ds_read_b64 v[20:21], v2 offset:160
    v_mfma_f32_16x16x32_bf16 v[160:163], v[128:131], v[48:51], v[160:163]
    ds_read_b64 v[22:23], v2 offset:168
    v_mfma_f32_16x16x32_bf16 v[164:167], v[132:135], v[48:51], v[164:167]
    ds_read_b128 v[84:87], v3 offset:21504
    v_mfma_f32_16x16x32_bf16 v[168:171], v[136:139], v[48:51], v[168:171]
    ds_read_b64 v[24:25], v2 offset:1280
    v_cvt_pk_bf16_f32 v176, v144, v145
    v_mfma_f32_16x16x32_bf16 v[172:175], v[140:143], v[48:51], v[172:175]
    ds_read_b64 v[26:27], v2 offset:1288
    v_cvt_pk_bf16_f32 v177, v146, v147
    v_mfma_f32_16x16x32_bf16 v[148:151], v[112:115], v[52:55], v[148:151]
    ds_read_b128 v[88:91], v3 offset:20992
    v_mfma_f32_16x16x32_bf16 v[152:155], v[116:119], v[52:55], v[152:155]
    ds_read_b64 v[28:29], v2 offset:1440
    v_mfma_f32_16x16x32_bf16 v[156:159], v[120:123], v[52:55], v[156:159]
    ds_read_b64 v[30:31], v2 offset:1448
    v_mfma_f32_16x16x32_bf16 v[160:163], v[124:127], v[52:55], v[160:163]
    ds_read_b128 v[92:95], v3 offset:20480
    v_mfma_f32_16x16x32_bf16 v[164:167], v[128:131], v[52:55], v[164:167]
    ds_read_b64 v[32:33], v2 offset:2560
    v_mfma_f32_16x16x32_bf16 v[168:171], v[132:135], v[52:55], v[168:171]
    ds_read_b64 v[34:35], v2 offset:2568
    v_cvt_pk_bf16_f32 v178, v148, v149
    v_mfma_f32_16x16x32_bf16 v[172:175], v[136:139], v[52:55], v[172:175]
    ds_read_b128 v[96:99], v3 offset:19968
    v_cvt_pk_bf16_f32 v179, v150, v151
    v_mfma_f32_16x16x32_bf16 v[152:155], v[112:115], v[56:59], v[152:155]
    ds_read_b64 v[36:37], v2 offset:2720
    v_mfma_f32_16x16x32_bf16 v[156:159], v[116:119], v[56:59], v[156:159]
    ds_read_b64 v[38:39], v2 offset:2728
    v_mfma_f32_16x16x32_bf16 v[160:163], v[120:123], v[56:59], v[160:163]
    ds_read_b128 v[100:103], v3 offset:19456
    v_mfma_f32_16x16x32_bf16 v[164:167], v[124:127], v[56:59], v[164:167]
    ds_read_b64 v[40:41], v2 offset:3840
    v_mfma_f32_16x16x32_bf16 v[168:171], v[128:131], v[56:59], v[168:171]
    ds_read_b64 v[42:43], v2 offset:3848
L_cpad1:
    s_cbranch_vccnz L_cwret
    v_mfma_f32_16x16x32_bf16 v[172:175], v[132:135], v[56:59], v[172:175]
    ds_read_b128 v[104:107], v3 offset:18944
    v_cvt_pk_bf16_f32 v180, v152, v153
    v_mfma_f32_16x16x32_bf16 v[156:159], v[112:115], v[60:63], v[156:159]
    ds_read_b64 v[44:45], v2 offset:4000
    v_cvt_pk_bf16_f32 v181, v154, v155
    v_mfma_f32_16x16x32_bf16 v[160:163], v[116:119], v[60:63], v[160:163]
    ds_read_b64 v[46:47], v2 offset:4008
    v_mfma_f32_16x16x32_bf16 v[164:167], v[120:123], v[60:63], v[164:167]
    ds_read_b128 v[108:111], v3 offset:18432
    v_mfma_f32_16x16x32_bf16 v[168:171], v[124:127], v[60:63], v[168:171]
    ds_write_b128 v6, v[176:179] offset:0
    v_mfma_f32_16x16x32_bf16 v[172:175], v[128:131], v[60:63], v[172:175]
    v_mfma_f32_16x16x32_bf16 v[160:163], v[112:115], v[64:67], v[160:163]
    v_cvt_pk_bf16_f32 v182, v156, v157
    v_mfma_f32_16x16x32_bf16 v[164:167], v[116:119], v[64:67], v[164:167]
    v_cvt_pk_bf16_f32 v183, v158, v159
    v_mfma_f32_16x16x32_bf16 v[168:171], v[120:123], v[64:67], v[168:171]
    v_mfma_f32_16x16x32_bf16 v[172:175], v[124:127], v[64:67], v[172:175]
    ds_write_b128 v6, v[180:183] offset:1024
    v_mfma_f32_16x16x32_bf16 v[164:167], v[112:115], v[68:71], v[164:167]
    v_add_u32 v3, 18432, v3
    v_mfma_f32_16x16x32_bf16 v[168:171], v[116:119], v[68:71], v[168:171]
    s_sub_u32 s17, s17, 1
    v_mfma_f32_16x16x32_bf16 v[172:175], v[120:123], v[68:71], v[172:175]
    v_cvt_pk_bf16_f32 v184, v160, v161
    v_mfma_f32_16x16x32_bf16 v[168:171], v[112:115], v[72:75], v[168:171]
    v_cvt_pk_bf16_f32 v185, v162, v163
    v_mfma_f32_16x16x32_bf16 v[172:175], v[116:119], v[72:75], v[172:175]
    s_cmp_lg_u32 s17, 0
    v_mfma_f32_16x16x32_bf16 v[172:175], v[112:115], v[76:79], v[172:175]
    v_cvt_pk_bf16_f32 v186, v164, v165
    v_cvt_pk_bf16_f32 v187, v166, v167
    ds_write_b128 v6, v[184:187] offset:2048
    s_nop 1
    v_cvt_pk_bf16_f32 v188, v168, v169
    v_cvt_pk_bf16_f32 v189, v170, v171
    s_nop 0
    v_cvt_pk_bf16_f32 v190, v172, v173
    v_cvt_pk_bf16_f32 v191, v174, v175
    ds_write_b128 v6, v[188:191] offset:3072
    v_add_u32 v6, 18432, v6
    s_cbranch_scc1 L_cm
    s_waitcnt lgkmcnt(0)
    s_barrier
    s_mov_b32 s6, 1
    s_branch L_early1
L_duty:
    s_lshl_b32 s48, s30, 2
    s_add_u32 s48, s48, s28
    s_sub_u32 s48, s48, 4
    s_lshl_b32 s48, s48, 9
    v_lshlrev_b32 v240, 3, v0
    v_mov_b32 v238, 0
    v_mov_b32 v239, 0
    s_add_u32 s44, s26, 30732800
    s_addc_u32 s45, s27, 0
    s_mov_b32 s46, 101632
    s_mov_b32 s47, 0x20000
    buffer_store_dwordx2 v[238:239], v240, s[44:47], s48 offen sc1
    s_cmp_ge_u32 s28, 6
    s_cbranch_scc1 L_st
    s_lshr_b32 s48, s34, 1
    s_mul_i32 s48, s48, 36
    s_and_b32 s49, s30, 15
    s_lshl_b32 s49, s49, 1
    s_add_u32 s48, s48, s49
    s_and_b32 s49, s28, 1
    s_add_u32 s48, s48, s49
L_cs:
    s_setprio 2
    s_cmp_lg_u32 s28, 3
    s_cbranch_scc1 L_csp
    s_setprio 3
L_csp:
    v_lshrrev_b32 v5, 3, v0
    v_and_b32 v6, 7, v0
    v_mul_u32_u24 v7, 9216, v5
    v_lshl_add_u32 v7, v6, 4, v7
    s_and_b32 s58, s48, 1
    s_lshr_b32 s48, s48, 1
    s_lshl_b32 s59, s48, 7
    s_mov_b32 s52, 2219876480
    s_mov_b32 s53, 1817
    s_cmp_eq_u32 s58, 1
    s_cselect_b32 s52, 3605345580, s52
    s_cselect_b32 s53, 4483, s53
    s_and_b32 s51, s34, 1
    s_cmp_eq_u32 s28, 3
    s_cselect_b32 s51, 0, s51
    s_mul_i32 s51, s51, 2
    s_mov_b32 s35, 0x3f80
    s_mov_b32 s54, 0x3f800000
    s_mov_b32 s40, s18
    s_mov_b32 s41, s19
    s_mov_b32 s42, 5308416
    s_mov_b32 s43, 0x20000
    s_add_u32 s44, s26, 30670848
    s_addc_u32 s45, s27, 0
    s_mov_b32 s46, 163584
    s_mov_b32 s47, 0x20000
    s_and_b32 s55, s52, 31
    s_lshr_b64 s[52:53], s[52:53], 5
    s_add_u32 s55, s55, s51
    s_cmp_ge_u32 s55, 18
    s_cselect_b32 s56, 18, 0
    s_sub_u32 s55, s55, s56
    s_mul_i32 s55, s55, 294912
    s_add_u32 s55, s55, s59
    buffer_load_dwordx4 v[16:19], v7, s[40:43], s55 offen
    s_add_u32 s55, s55, 73728
    buffer_load_dwordx4 v[20:23], v7, s[40:43], s55 offen
    s_add_u32 s55, s55, 73728
    buffer_load_dwordx4 v[24:27], v7, s[40:43], s55 offen
    s_add_u32 s55, s55, 73728
    buffer_load_dwordx4 v[28:31], v7, s[40:43], s55 offen
    s_and_b32 s55, s52, 31
    s_lshr_b64 s[52:53], s[52:53], 5
    s_add_u32 s55, s55, s51
    s_cmp_ge_u32 s55, 18
    s_cselect_b32 s56, 18, 0
    s_sub_u32 s55, s55, s56
    s_mul_i32 s55, s55, 294912
    s_add_u32 s55, s55, s59
    buffer_load_dwordx4 v[32:35], v7, s[40:43], s55 offen
    s_add_u32 s55, s55, 73728
    buffer_load_dwordx4 v[36:39], v7, s[40:43], s55 offen
    s_add_u32 s55, s55, 73728
    buffer_load_dwordx4 v[40:43], v7, s[40:43], s55 offen
    s_add_u32 s55, s55, 73728
    buffer_load_dwordx4 v[44:47], v7, s[40:43], s55 offen
    v_mov_b32 v96, 0
    v_mov_b32 v97, 0
    v_mov_b32 v98, 0
    v_mov_b32 v99, 0
    v_mov_b32 v100, 0
    v_mov_b32 v101, 0
    v_mov_b32 v102, 0
    v_mov_b32 v103, 0
    s_mov_b32 s57, 2
L_h1:
    s_cmp_eq_u32 s57, 0
    s_and_b32 s55, s52, 31
    s_lshr_b64 s[52:53], s[52:53], 5
    s_add_u32 s55, s55, s51
    s_cmp_ge_u32 s55, 18
    s_cselect_b32 s56, 18, 0
    s_sub_u32 s55, s55, s56
    s_mul_i32 s55, s55, 294912
    s_add_u32 s55, s55, s59
    buffer_load_dwordx4 v[48:51], v7, s[40:43], s55 offen
    s_add_u32 s55, s55, 73728
    buffer_load_dwordx4 v[52:55], v7, s[40:43], s55 offen
    s_add_u32 s55, s55, 73728
    buffer_load_dwordx4 v[56:59], v7, s[40:43], s55 offen
    s_add_u32 s55, s55, 73728
    buffer_load_dwordx4 v[60:63], v7, s[40:43], s55 offen
    s_waitcnt vmcnt(8)
    v_dot2c_f32_bf16 v96, s35, v16
    v_dot2c_f32_bf16 v97, s54, v16
    v_dot2c_f32_bf16 v98, s35, v17
    v_dot2c_f32_bf16 v99, s54, v17
    v_dot2c_f32_bf16 v100, s35, v18
    v_dot2c_f32_bf16 v101, s54, v18
    v_dot2c_f32_bf16 v102, s35, v19
    v_dot2c_f32_bf16 v103, s54, v19
    v_dot2c_f32_bf16 v96, s35, v20
    v_dot2c_f32_bf16 v97, s54, v20
    v_dot2c_f32_bf16 v98, s35, v21
    v_dot2c_f32_bf16 v99, s54, v21
    v_dot2c_f32_bf16 v100, s35, v22
    v_dot2c_f32_bf16 v101, s54, v22
    v_dot2c_f32_bf16 v102, s35, v23
    v_dot2c_f32_bf16 v103, s54, v23
    v_dot2c_f32_bf16 v96, s35, v24
    v_dot2c_f32_bf16 v97, s54, v24
    v_dot2c_f32_bf16 v98, s35, v25
    v_dot2c_f32_bf16 v99, s54, v25
    v_dot2c_f32_bf16 v100, s35, v26
    v_dot2c_f32_bf16 v101, s54, v26
    v_dot2c_f32_bf16 v102, s35, v27
    v_dot2c_f32_bf16 v103, s54, v27
    v_dot2c_f32_bf16 v96, s35, v28
    v_dot2c_f32_bf16 v97, s54, v28
    v_dot2c_f32_bf16 v98, s35, v29
    v_dot2c_f32_bf16 v99, s54, v29
    v_dot2c_f32_bf16 v100, s35, v30
    v_dot2c_f32_bf16 v101, s54, v30
    v_dot2c_f32_bf16 v102, s35, v31
    v_dot2c_f32_bf16 v103, s54, v31
    s_cmp_eq_u32 s57, 0
    s_cbranch_scc1 L_h1w1
    s_and_b32 s55, s52, 31
    s_lshr_b64 s[52:53], s[52:53], 5
    s_add_u32 s55, s55, s51
    s_cmp_ge_u32 s55, 18
    s_cselect_b32 s56, 18, 0
    s_sub_u32 s55, s55, s56
    s_mul_i32 s55, s55, 294912
    s_add_u32 s55, s55, s59
    buffer_load_dwordx4 v[16:19], v7, s[40:43], s55 offen
    s_add_u32 s55, s55, 73728
    buffer_load_dwordx4 v[20:23], v7, s[40:43], s55 offen
    s_add_u32 s55, s55, 73728
    buffer_load_dwordx4 v[24:27], v7, s[40:43], s55 offen
    s_add_u32 s55, s55, 73728
    buffer_load_dwordx4 v[28:31], v7, s[40:43], s55 offen
    s_waitcnt vmcnt(8)
    s_branch L_h1c1
L_h1w1:
    s_cmp_eq_u32 s28, 3
    s_cbranch_scc1 L_h1h
    s_barrier
L_h1h:
    s_waitcnt vmcnt(4)
L_h1c1:
    v_dot2c_f32_bf16 v96, s35, v32
    v_dot2c_f32_bf16 v97, s54, v32
    v_dot2c_f32_bf16 v98, s35, v33
    v_dot2c_f32_bf16 v99, s54, v33
    v_dot2c_f32_bf16 v100, s35, v34
    v_dot2c_f32_bf16 v101, s54, v34
    v_dot2c_f32_bf16 v102, s35, v35
    v_dot2c_f32_bf16 v103, s54, v35
    v_dot2c_f32_bf16 v96, s35, v36
    v_dot2c_f32_bf16 v97, s54, v36
    v_dot2c_f32_bf16 v98, s35, v37
    v_dot2c_f32_bf16 v99, s54, v37
    v_dot2c_f32_bf16 v100, s35, v38
    v_dot2c_f32_bf16 v101, s54, v38
    v_dot2c_f32_bf16 v102, s35, v39
    v_dot2c_f32_bf16 v103, s54, v39
    v_dot2c_f32_bf16 v96, s35, v40
    v_dot2c_f32_bf16 v97, s54, v40
    v_dot2c_f32_bf16 v98, s35, v41
    v_dot2c_f32_bf16 v99, s54, v41
    v_dot2c_f32_bf16 v100, s35, v42
    v_dot2c_f32_bf16 v101, s54, v42
    v_dot2c_f32_bf16 v102, s35, v43
    v_dot2c_f32_bf16 v103, s54, v43
    v_dot2c_f32_bf16 v96, s35, v44
    v_dot2c_f32_bf16 v97, s54, v44
    v_dot2c_f32_bf16 v98, s35, v45
    v_dot2c_f32_bf16 v99, s54, v45
    v_dot2c_f32_bf16 v100, s35, v46
    v_dot2c_f32_bf16 v101, s54, v46
    v_dot2c_f32_bf16 v102, s35, v47
    v_dot2c_f32_bf16 v103, s54, v47
    s_cmp_eq_u32 s57, 0
    s_cbranch_scc1 L_h1w2
    s_and_b32 s55, s52, 31
    s_lshr_b64 s[52:53], s[52:53], 5
    s_add_u32 s55, s55, s51
    s_cmp_ge_u32 s55, 18
    s_cselect_b32 s56, 18, 0
    s_sub_u32 s55, s55, s56
    s_mul_i32 s55, s55, 294912
    s_add_u32 s55, s55, s59
    buffer_load_dwordx4 v[32:35], v7, s[40:43], s55 offen
    s_add_u32 s55, s55, 73728
    buffer_load_dwordx4 v[36:39], v7, s[40:43], s55 offen
    s_add_u32 s55, s55, 73728
    buffer_load_dwordx4 v[40:43], v7, s[40:43], s55 offen
    s_add_u32 s55, s55, 73728
    buffer_load_dwordx4 v[44:47], v7, s[40:43], s55 offen
    s_waitcnt vmcnt(8)
    s_branch L_h1c2
L_h1w2:
    s_waitcnt vmcnt(0)
L_h1c2:
    v_dot2c_f32_bf16 v96, s35, v48
    v_dot2c_f32_bf16 v97, s54, v48
    v_dot2c_f32_bf16 v98, s35, v49
    v_dot2c_f32_bf16 v99, s54, v49
    v_dot2c_f32_bf16 v100, s35, v50
    v_dot2c_f32_bf16 v101, s54, v50
    v_dot2c_f32_bf16 v102, s35, v51
    v_dot2c_f32_bf16 v103, s54, v51
    v_dot2c_f32_bf16 v96, s35, v52
    v_dot2c_f32_bf16 v97, s54, v52
    v_dot2c_f32_bf16 v98, s35, v53
    v_dot2c_f32_bf16 v99, s54, v53
    v_dot2c_f32_bf16 v100, s35, v54
    v_dot2c_f32_bf16 v101, s54, v54
    v_dot2c_f32_bf16 v102, s35, v55
    v_dot2c_f32_bf16 v103, s54, v55
    v_dot2c_f32_bf16 v96, s35, v56
    v_dot2c_f32_bf16 v97, s54, v56
    v_dot2c_f32_bf16 v98, s35, v57
    v_dot2c_f32_bf16 v99, s54, v57
    v_dot2c_f32_bf16 v100, s35, v58
    v_dot2c_f32_bf16 v101, s54, v58
    v_dot2c_f32_bf16 v102, s35, v59
    v_dot2c_f32_bf16 v103, s54, v59
    v_dot2c_f32_bf16 v96, s35, v60
    v_dot2c_f32_bf16 v97, s54, v60
    v_dot2c_f32_bf16 v98, s35, v61
    v_dot2c_f32_bf16 v99, s54, v61
    v_dot2c_f32_bf16 v100, s35, v62
    v_dot2c_f32_bf16 v101, s54, v62
    v_dot2c_f32_bf16 v102, s35, v63
    v_dot2c_f32_bf16 v103, s54, v63
    s_sub_u32 s57, s57, 1
    s_cbranch_scc0 L_h1
    s_nop 2
    v_add_f32_dpp v96, v96, v96 row_ror:8 row_mask:0xf bank_mask:0xf
    v_add_f32_dpp v97, v97, v97 row_ror:8 row_mask:0xf bank_mask:0xf
    v_add_f32_dpp v98, v98, v98 row_ror:8 row_mask:0xf bank_mask:0xf
    v_add_f32_dpp v99, v99, v99 row_ror:8 row_mask:0xf bank_mask:0xf
    v_add_f32_dpp v100, v100, v100 row_ror:8 row_mask:0xf bank_mask:0xf
    v_add_f32_dpp v101, v101, v101 row_ror:8 row_mask:0xf bank_mask:0xf
    v_add_f32_dpp v102, v102, v102 row_ror:8 row_mask:0xf bank_mask:0xf
    v_add_f32_dpp v103, v103, v103 row_ror:8 row_mask:0xf bank_mask:0xf
    v_mov_b32 v16, v96
    v_mov_b32 v17, v97
    v_mov_b32 v18, v98
    v_mov_b32 v19, v99
    v_mov_b32 v20, v100
    v_mov_b32 v21, v101
    v_mov_b32 v22, v102
    v_mov_b32 v23, v103
    s_nop 0
    v_permlane16_swap_b32 v16, v96
    v_permlane16_swap_b32 v17, v97
    v_permlane16_swap_b32 v18, v98
    v_permlane16_swap_b32 v19, v99
    v_permlane16_swap_b32 v20, v100
    v_permlane16_swap_b32 v21, v101
    v_permlane16_swap_b32 v22, v102
    v_permlane16_swap_b32 v23, v103
    v_add_f32 v96, v96, v16
    v_add_f32 v97, v97, v17
    v_add_f32 v98, v98, v18
    v_add_f32 v99, v99, v19
    v_add_f32 v100, v100, v20
    v_add_f32 v101, v101, v21
    v_add_f32 v102, v102, v22
    v_add_f32 v103, v103, v23
    v_mov_b32 v16, v96
    v_mov_b32 v17, v97
    v_mov_b32 v18, v98
    v_mov_b32 v19, v99
    v_mov_b32 v20, v100
    v_mov_b32 v21, v101
    v_mov_b32 v22, v102
    v_mov_b32 v23, v103
    s_nop 0
    v_permlane32_swap_b32 v16, v96
    v_permlane32_swap_b32 v17, v97
    v_permlane32_swap_b32 v18, v98
    v_permlane32_swap_b32 v19, v99
    v_permlane32_swap_b32 v20, v100
    v_permlane32_swap_b32 v21, v101
    v_permlane32_swap_b32 v22, v102
    v_permlane32_swap_b32 v23, v103
    v_add_f32 v96, v96, v16
    v_add_f32 v97, v97, v17
    v_add_f32 v98, v98, v18
    v_add_f32 v99, v99, v19
    v_add_f32 v100, v100, v20
    v_add_f32 v101, v101, v21
    v_add_f32 v102, v102, v22
    v_add_f32 v103, v103, v23
    v_cmp_eq_u32 vcc, 1, v5
    s_nop 1
    v_cndmask_b32 v96, v96, v97, vcc
    v_cmp_eq_u32 vcc, 2, v5
    s_nop 1
    v_cndmask_b32 v96, v96, v98, vcc
    v_cmp_eq_u32 vcc, 3, v5
    s_nop 1
    v_cndmask_b32 v96, v96, v99, vcc
    v_cmp_eq_u32 vcc, 4, v5
    s_nop 1
    v_cndmask_b32 v96, v96, v100, vcc
    v_cmp_eq_u32 vcc, 5, v5
    s_nop 1
    v_cndmask_b32 v96, v96, v101, vcc
    v_cmp_eq_u32 vcc, 6, v5
    s_nop 1
    v_cndmask_b32 v96, v96, v102, vcc
    v_cmp_eq_u32 vcc, 7, v5
    s_nop 1
    v_cndmask_b32 v96, v96, v103, vcc
    v_cvt_pk_bf16_f32 v12, v96, v96
    v_lshlrev_b32 v12, 16, v12
    v_sub_f32 v13, v96, v12
    v_cvt_pk_bf16_f32 v12, v12, v13
    v_lshrrev_b32 v10, 2, v6
    v_lshlrev_b32 v10, 8, v10
    v_and_b32 v11, 1, v6
    v_lshl_add_u32 v11, v11, 3, v5
    v_lshl_add_u32 v10, v11, 4, v10
    v_and_b32 v11, 2, v6
    v_lshl_add_u32 v10, v11, 2, v10
    s_lshl_b32 s48, s48, 9
    s_lshl_b32 s49, s58, 2
    s_add_u32 s48, s48, s49
    buffer_store_dword v12, v10, s[44:47], s48 offen sc1
    s_mov_b32 s65, -2
    s_setprio 0
    s_cmp_eq_u32 s28, 3
    s_cbranch_scc1 L_kv0
    s_mov_b32 s52, s12
    s_mov_b32 s53, s13
    s_mov_b32 s54, 2359296
    s_mov_b32 s55, 0x20000
    s_branch L_sea
L_st:
    v_lshrrev_b32 v1, 2, v0
    v_mul_u32_u24 v2, 1152, v1
    v_and_b32 v3, 3, v0
    v_lshl_add_u32 v2, v3, 4, v2
    v_lshlrev_b32 v1, 3, v1
    v_cmp_ne_u32 vcc, 0, v3
    v_bfrev_b32 v8, 1
    s_mov_b32 s35, 0xffff0000
    s_mov_b32 s54, 0x3f803f80
    v_cndmask_b32 v1, v1, v8, vcc
    s_and_b32 s58, s34, 1
    s_lshl_b32 s58, s58, 2
    s_lshr_b32 s48, s34, 1
    s_add_u32 s58, s58, s48
    s_lshl_b32 s58, s58, 3
    s_and_b32 s48, s30, 7
    s_add_u32 s58, s58, s48
    s_lshl_b32 s58, s58, 1
    s_and_b32 s48, s28, 1
    s_add_u32 s58, s58, s48
    s_mov_b32 s36, s4
    s_mov_b32 s37, s5
    s_mov_b32 s38, 2359296
    s_mov_b32 s39, 0x20000
    s_add_u32 s44, s26, 30670848
    s_addc_u32 s45, s27, 0
    s_mov_b32 s46, 61952
    s_mov_b32 s47, 0x20000
    v_lshrrev_b32 v4, 1, v1
    s_mul_i32 s48, s58, 18432
    buffer_load_dwordx4 v[16:19], v2, s[36:39], s48 offen offset:0
    buffer_load_dwordx4 v[20:23], v2, s[36:39], s48 offen offset:64
    buffer_load_dwordx4 v[24:27], v2, s[36:39], s48 offen offset:128
    buffer_load_dwordx4 v[28:31], v2, s[36:39], s48 offen offset:192
    buffer_load_dwordx4 v[32:35], v2, s[36:39], s48 offen offset:256
    buffer_load_dwordx4 v[36:39], v2, s[36:39], s48 offen offset:320
    buffer_load_dwordx4 v[40:43], v2, s[36:39], s48 offen offset:384
    buffer_load_dwordx4 v[44:47], v2, s[36:39], s48 offen offset:448
    buffer_load_dwordx4 v[48:51], v2, s[36:39], s48 offen offset:512
    buffer_load_dwordx4 v[52:55], v2, s[36:39], s48 offen offset:576
    buffer_load_dwordx4 v[56:59], v2, s[36:39], s48 offen offset:640
    buffer_load_dwordx4 v[60:63], v2, s[36:39], s48 offen offset:704
    buffer_load_dwordx4 v[64:67], v2, s[36:39], s48 offen offset:768
    buffer_load_dwordx4 v[68:71], v2, s[36:39], s48 offen offset:832
    buffer_load_dwordx4 v[72:75], v2, s[36:39], s48 offen offset:896
    buffer_load_dwordx4 v[76:79], v2, s[36:39], s48 offen offset:960
    buffer_load_dwordx4 v[80:83], v2, s[36:39], s48 offen offset:1024
    buffer_load_dwordx4 v[84:87], v2, s[36:39], s48 offen offset:1088
    v_mov_b32 v9, 0
    v_mov_b32 v10, 0
    v_mov_b32 v11, 0
    v_mov_b32 v12, 0
    s_waitcnt vmcnt(17)
    v_dot2c_f32_bf16 v9, s54, v16
    v_dot2c_f32_bf16 v10, v16, v16
    v_dot2c_f32_bf16 v11, s54, v17
    v_dot2c_f32_bf16 v12, v17, v17
    v_dot2c_f32_bf16 v9, s54, v18
    v_dot2c_f32_bf16 v10, v18, v18
    v_dot2c_f32_bf16 v11, s54, v19
    v_dot2c_f32_bf16 v12, v19, v19
    s_waitcnt vmcnt(16)
    v_dot2c_f32_bf16 v9, s54, v20
    v_dot2c_f32_bf16 v10, v20, v20
    v_dot2c_f32_bf16 v11, s54, v21
    v_dot2c_f32_bf16 v12, v21, v21
    v_dot2c_f32_bf16 v9, s54, v22
    v_dot2c_f32_bf16 v10, v22, v22
    v_dot2c_f32_bf16 v11, s54, v23
    v_dot2c_f32_bf16 v12, v23, v23
    s_waitcnt vmcnt(15)
    v_dot2c_f32_bf16 v9, s54, v24
    v_dot2c_f32_bf16 v10, v24, v24
    v_dot2c_f32_bf16 v11, s54, v25
    v_dot2c_f32_bf16 v12, v25, v25
    v_dot2c_f32_bf16 v9, s54, v26
    v_dot2c_f32_bf16 v10, v26, v26
    v_dot2c_f32_bf16 v11, s54, v27
    v_dot2c_f32_bf16 v12, v27, v27
    s_waitcnt vmcnt(14)
    v_dot2c_f32_bf16 v9, s54, v28
    v_dot2c_f32_bf16 v10, v28, v28
    v_dot2c_f32_bf16 v11, s54, v29
    v_dot2c_f32_bf16 v12, v29, v29
    v_dot2c_f32_bf16 v9, s54, v30
    v_dot2c_f32_bf16 v10, v30, v30
    v_dot2c_f32_bf16 v11, s54, v31
    v_dot2c_f32_bf16 v12, v31, v31
    s_waitcnt vmcnt(13)
    v_dot2c_f32_bf16 v9, s54, v32
    v_dot2c_f32_bf16 v10, v32, v32
    v_dot2c_f32_bf16 v11, s54, v33
    v_dot2c_f32_bf16 v12, v33, v33
    v_dot2c_f32_bf16 v9, s54, v34
    v_dot2c_f32_bf16 v10, v34, v34
    v_dot2c_f32_bf16 v11, s54, v35
    v_dot2c_f32_bf16 v12, v35, v35
    s_waitcnt vmcnt(12)
    v_dot2c_f32_bf16 v9, s54, v36
    v_dot2c_f32_bf16 v10, v36, v36
    v_dot2c_f32_bf16 v11, s54, v37
    v_dot2c_f32_bf16 v12, v37, v37
    v_dot2c_f32_bf16 v9, s54, v38
    v_dot2c_f32_bf16 v10, v38, v38
    v_dot2c_f32_bf16 v11, s54, v39
    v_dot2c_f32_bf16 v12, v39, v39
    s_waitcnt vmcnt(11)
    v_dot2c_f32_bf16 v9, s54, v40
    v_dot2c_f32_bf16 v10, v40, v40
    v_dot2c_f32_bf16 v11, s54, v41
    v_dot2c_f32_bf16 v12, v41, v41
    v_dot2c_f32_bf16 v9, s54, v42
    v_dot2c_f32_bf16 v10, v42, v42
    v_dot2c_f32_bf16 v11, s54, v43
    v_dot2c_f32_bf16 v12, v43, v43
    s_waitcnt vmcnt(10)
    v_dot2c_f32_bf16 v9, s54, v44
    v_dot2c_f32_bf16 v10, v44, v44
    v_dot2c_f32_bf16 v11, s54, v45
    v_dot2c_f32_bf16 v12, v45, v45
    v_dot2c_f32_bf16 v9, s54, v46
    v_dot2c_f32_bf16 v10, v46, v46
    v_dot2c_f32_bf16 v11, s54, v47
    v_dot2c_f32_bf16 v12, v47, v47
    s_waitcnt vmcnt(9)
    v_dot2c_f32_bf16 v9, s54, v48
    v_dot2c_f32_bf16 v10, v48, v48
    v_dot2c_f32_bf16 v11, s54, v49
    v_dot2c_f32_bf16 v12, v49, v49
    v_dot2c_f32_bf16 v9, s54, v50
    v_dot2c_f32_bf16 v10, v50, v50
    v_dot2c_f32_bf16 v11, s54, v51
    v_dot2c_f32_bf16 v12, v51, v51
    s_waitcnt vmcnt(8)
    v_dot2c_f32_bf16 v9, s54, v52
    v_dot2c_f32_bf16 v10, v52, v52
    v_dot2c_f32_bf16 v11, s54, v53
    v_dot2c_f32_bf16 v12, v53, v53
    v_dot2c_f32_bf16 v9, s54, v54
    v_dot2c_f32_bf16 v10, v54, v54
    v_dot2c_f32_bf16 v11, s54, v55
    v_dot2c_f32_bf16 v12, v55, v55
    s_waitcnt vmcnt(7)
    v_dot2c_f32_bf16 v9, s54, v56
    v_dot2c_f32_bf16 v10, v56, v56
    v_dot2c_f32_bf16 v11, s54, v57
    v_dot2c_f32_bf16 v12, v57, v57
    v_dot2c_f32_bf16 v9, s54, v58
    v_dot2c_f32_bf16 v10, v58, v58
    v_dot2c_f32_bf16 v11, s54, v59
    v_dot2c_f32_bf16 v12, v59, v59
    s_waitcnt vmcnt(6)
    v_dot2c_f32_bf16 v9, s54, v60
    v_dot2c_f32_bf16 v10, v60, v60
    v_dot2c_f32_bf16 v11, s54, v61
    v_dot2c_f32_bf16 v12, v61, v61
    v_dot2c_f32_bf16 v9, s54, v62
    v_dot2c_f32_bf16 v10, v62, v62
    v_dot2c_f32_bf16 v11, s54, v63
    v_dot2c_f32_bf16 v12, v63, v63
    s_waitcnt vmcnt(5)
    v_dot2c_f32_bf16 v9, s54, v64
    v_dot2c_f32_bf16 v10, v64, v64
    v_dot2c_f32_bf16 v11, s54, v65
    v_dot2c_f32_bf16 v12, v65, v65
    v_dot2c_f32_bf16 v9, s54, v66
    v_dot2c_f32_bf16 v10, v66, v66
    v_dot2c_f32_bf16 v11, s54, v67
    v_dot2c_f32_bf16 v12, v67, v67
    s_waitcnt vmcnt(4)
    v_dot2c_f32_bf16 v9, s54, v68
    v_dot2c_f32_bf16 v10, v68, v68
    v_dot2c_f32_bf16 v11, s54, v69
    v_dot2c_f32_bf16 v12, v69, v69
    v_dot2c_f32_bf16 v9, s54, v70
    v_dot2c_f32_bf16 v10, v70, v70
    v_dot2c_f32_bf16 v11, s54, v71
    v_dot2c_f32_bf16 v12, v71, v71
    s_waitcnt vmcnt(3)
    v_dot2c_f32_bf16 v9, s54, v72
    v_dot2c_f32_bf16 v10, v72, v72
    v_dot2c_f32_bf16 v11, s54, v73
    v_dot2c_f32_bf16 v12, v73, v73
    v_dot2c_f32_bf16 v9, s54, v74
    v_dot2c_f32_bf16 v10, v74, v74
    v_dot2c_f32_bf16 v11, s54, v75
    v_dot2c_f32_bf16 v12, v75, v75
    s_waitcnt vmcnt(2)
    v_dot2c_f32_bf16 v9, s54, v76
    v_dot2c_f32_bf16 v10, v76, v76
    v_dot2c_f32_bf16 v11, s54, v77
    v_dot2c_f32_bf16 v12, v77, v77
    v_dot2c_f32_bf16 v9, s54, v78
    v_dot2c_f32_bf16 v10, v78, v78
    v_dot2c_f32_bf16 v11, s54, v79
    v_dot2c_f32_bf16 v12, v79, v79
    s_waitcnt vmcnt(1)
    v_dot2c_f32_bf16 v9, s54, v80
    v_dot2c_f32_bf16 v10, v80, v80
    v_dot2c_f32_bf16 v11, s54, v81
    v_dot2c_f32_bf16 v12, v81, v81
    v_dot2c_f32_bf16 v9, s54, v82
    v_dot2c_f32_bf16 v10, v82, v82
    v_dot2c_f32_bf16 v11, s54, v83
    v_dot2c_f32_bf16 v12, v83, v83
    s_waitcnt vmcnt(0)
    v_dot2c_f32_bf16 v9, s54, v84
    v_dot2c_f32_bf16 v10, v84, v84
    v_dot2c_f32_bf16 v11, s54, v85
    v_dot2c_f32_bf16 v12, v85, v85
    v_dot2c_f32_bf16 v9, s54, v86
    v_dot2c_f32_bf16 v10, v86, v86
    v_dot2c_f32_bf16 v11, s54, v87
    v_dot2c_f32_bf16 v12, v87, v87
    s_nop 2
    v_add_f32 v9, v9, v11
    v_add_f32 v10, v10, v12
    s_nop 0
    v_add_f32_dpp v9, v9, v9 quad_perm:[1,0,3,2] row_mask:0xf bank_mask:0xf
    v_add_f32_dpp v10, v10, v10 quad_perm:[1,0,3,2] row_mask:0xf bank_mask:0xf
    s_nop 0
    v_add_f32_dpp v9, v9, v9 quad_perm:[2,3,0,1] row_mask:0xf bank_mask:0xf
    v_add_f32_dpp v10, v10, v10 quad_perm:[2,3,0,1] row_mask:0xf bank_mask:0xf
    v_mul_f32 v9, 0x3ae38e39, v9
    v_mul_f32 v10, 0x3ae38e39, v10
    v_fma_f32 v10, -v9, v9, v10
    v_max_f32 v10, 0, v10
    v_cvt_pk_bf16_f32 v10, v10, v9
    v_and_b32 v12, s35, v10
    v_lshlrev_b32 v10, 16, v10
    v_add_f32 v10, 0x3727c5ac, v10
    v_cvt_pk_bf16_f32 v10, v10, v10
    v_lshlrev_b32 v10, 16, v10
    v_sqrt_f32 v10, v10
    s_lshl_b32 s49, s58, 7
    v_cvt_pk_bf16_f32 v10, v10, v10
    v_lshlrev_b32 v10, 16, v10
    v_rcp_f32 v13, v10
    s_add_u32 s49, s49, 36864
    v_cvt_pk_bf16_f32 v14, -v12, -v12
    buffer_store_dwordx2 v[12:13], v1, s[44:47], s49 offen sc1
    s_lshl_b32 s49, s58, 6
    s_add_u32 s49, s49, 53248
    buffer_store_dword v14, v4, s[44:47], s49 offen sc1
    s_mov_b32 s52, s12
    s_mov_b32 s53, s13
    s_mov_b32 s54, 2359296
    s_mov_b32 s55, 0x20000
    s_barrier
    v_lshlrev_b32 v9, 7, v0
    s_and_b32 s48, s28, 1
    s_add_u32 s62, s50, s48
    s_sub_u32 s62, s62, 2
    s_lshl_b32 s62, s62, 12
    s_setprio 2
    buffer_load_dword v238, v9, s[52:55], s62 offen
    s_setprio 0
    s_cmp_eq_u32 s29, 0
    s_cbranch_scc1 L_sea
    s_add_u32 s62, s16, s48
    s_sub_u32 s62, s62, 2
    s_lshl_b32 s62, s62, 12
    buffer_load_dword v239, v9, s[52:55], s62 offen
    s_branch L_sea
L_early:
    s_mov_b32 s6, 0
L_early1:
    s_setprio 0
    v_and_b32 v1, 15, v0
    v_lshrrev_b32 v2, 4, v0
    v_mul_u32_u24 v4, 1152, v1
    v_and_b32 v5, 1, v2
    v_lshl_add_u32 v4, v5, 5, v4
    v_lshrrev_b32 v5, 1, v2
    v_lshl_add_u32 v249, v5, 4, v4
    v_lshlrev_b32 v250, 3, v1
    v_lshlrev_b32 v4, 7, v0
    v_bfrev_b32 v5, 1
    s_mov_b64 s[64:65], 1
    s_mov_b64 s[66:67], 0xff
    v_cndmask_b32 v254, v5, v4, s[66:67]
    v_cndmask_b32 v253, v5, v4, s[64:65]
    v_lshlrev_b32 v248, 4, v0
    s_mov_b32 s40, s4
    s_mov_b32 s41, s5
    s_mov_b32 s42, 2359296
    s_mov_b32 s43, 0x20000
    v_lshrrev_b32 v1, 2, v0
    v_and_b32 v2, 3, v0
    v_mul_u32_u24 v4, 1152, v1
    v_lshl_add_u32 v251, v2, 4, v4
    v_and_b32 v4, 1, v2
    v_lshl_add_u32 v1, v4, 5, v1
    v_lshrrev_b32 v4, 1, v2
    v_lshl_add_u32 v1, v4, 4, v1
    v_lshlrev_b32 v252, 2, v1
    s_mov_b32 s35, 0xffff0000
    s_mov_b32 s60, s22
    s_mov_b32 s61, s23
    s_mov_b32 s62, 2359296
    s_mov_b32 s63, 0x20000
    s_mov_b32 s36, s26
    s_mov_b32 s37, s27
    s_mov_b32 s38, 33193728
    s_mov_b32 s39, 0x20000
    s_lshl_b32 s7, s33, 3
    s_add_u32 s7, s7, s28
    s_cmp_lg_u32 s29, 0
    s_cbranch_scc1 L_earlc
    s_add_u32 s7, s7, 640
    s_lshr_b32 s13, s7, 8
    s_bfe_u32 s64, s7, 0x70001
    s_and_b32 s65, s7, 1
    s_lshr_b32 s66, s64, 3
    s_and_b32 s66, s66, 7
    s_mul_i32 s66, s66, 1
    s_add_u32 s66, s66, s13
    s_cmp_ge_u32 s66, 9
    s_cselect_b32 s67, 9, 0
    s_sub_u32 s66, s66, s67
    s_lshr_b32 s67, s64, 1
    s_lshl_b32 s12, s67, 7
    s_mul_i32 s67, s67, 9
    s_add_u32 s67, s67, s66
    s_lshl_b32 s67, s67, 12
    s_and_b32 s11, s7, 3
    s_lshl_b32 s11, s11, 10
    s_mul_i32 s8, s67, 12
    s_add_u32 s8, s8, s11
    s_lshl_b32 s9, s65, 11
    s_add_u32 s9, s9, s67
    s_add_u32 s9, s9, 28311552
    s_lshl_b32 s66, s66, 1
    s_add_u32 s66, s66, s65
    s_mul_i32 s10, s64, 18432
    s_lshl_b32 s67, s66, 6
    s_add_u32 s10, s10, s67
    s_lshl_b32 s11, s64, 7
    s_add_u32 s11, s11, 30707712
    s_add_u32 s67, s13, 1
    s_mul_i32 s67, s67, 8192
    s_add_u32 s12, s12, s67
    s_add_u32 s12, s12, 30732800
    s_bitcmp1_b32 s7, 1
    s_cselect_b32 s13, 0x02020000, 0
    s_add_u32 s13, s13, 0x01000c0c
    s_lshr_b32 s67, s66, 1
    s_sub_u32 s66, s66, 8
    s_max_i32 s66, s66, s67
    s_lshl_b32 s14, s66, 10
    s_add_u32 s14, s14, 30822912
    s_add_u32 s7, s7, 384
    s_lshr_b32 s55, s7, 8
    s_bfe_u32 s64, s7, 0x70001
    s_and_b32 s65, s7, 1
    s_lshr_b32 s66, s64, 3
    s_and_b32 s66, s66, 7
    s_mul_i32 s66, s66, 1
    s_add_u32 s66, s66, s55
    s_cmp_ge_u32 s66, 9
    s_cselect_b32 s67, 9, 0
    s_sub_u32 s66, s66, s67
    s_lshr_b32 s67, s64, 1
    s_lshl_b32 s54, s67, 7
    s_mul_i32 s67, s67, 9
    s_add_u32 s67, s67, s66
    s_lshl_b32 s67, s67, 12
    s_and_b32 s53, s7, 3
    s_lshl_b32 s53, s53, 10
    s_mul_i32 s50, s67, 12
    s_add_u32 s50, s50, s53
    s_lshl_b32 s51, s65, 11
    s_add_u32 s51, s51, s67
    s_add_u32 s51, s51, 28311552
    s_lshl_b32 s66, s66, 1
    s_add_u32 s66, s66, s65
    s_mul_i32 s52, s64, 18432
    s_lshl_b32 s67, s66, 6
    s_add_u32 s52, s52, s67
    s_lshl_b32 s53, s64, 7
    s_add_u32 s53, s53, 30707712
    s_add_u32 s67, s55, 1
    s_mul_i32 s67, s67, 8192
    s_add_u32 s54, s54, s67
    s_add_u32 s54, s54, 30732800
    s_bitcmp1_b32 s7, 1
    s_cselect_b32 s55, 0x02020000, 0
    s_add_u32 s55, s55, 0x01000c0c
    s_lshr_b32 s67, s66, 1
    s_sub_u32 s66, s66, 8
    s_max_i32 s66, s66, s67
    s_lshl_b32 s56, s66, 10
    s_add_u32 s56, s56, 30822912
    s_cmp_eq_u32 s6, 0
    s_cbranch_scc1 L_nxh
    s_barrier
L_nxh:
L_resh0:
    v_mov_b32 v2, 0
    buffer_atomic_add v2, v253, s[36:39], s12 offen sc0 sc1
    s_waitcnt vmcnt(0)
    v_readfirstlane_b32 s3, v2
    s_nop 0
    s_cmp_ge_u32 s3, 12
    s_cbranch_scc1 L_reth0
    s_sleep 4
    s_sub_u32 s74, s74, 1
    s_cbranch_scc0 L_resh0
    s_mov_b32 s74, 0
L_reth0:
    s_mov_b32 s64, s8
    buffer_load_dwordx4 v[16:19], v248, s[36:39], s64 offen sc1
    s_add_u32 s64, s64, 4096
    buffer_load_dwordx4 v[20:23], v248, s[36:39], s64 offen sc1
    s_add_u32 s64, s64, 4096
    buffer_load_dwordx4 v[24:27], v248, s[36:39], s64 offen sc1
    s_add_u32 s64, s64, 4096
    buffer_load_dwordx4 v[28:31], v248, s[36:39], s64 offen sc1
    s_add_u32 s64, s64, 4096
    buffer_load_dwordx4 v[32:35], v248, s[36:39], s64 offen sc1
    s_add_u32 s64, s64, 4096
    buffer_load_dwordx4 v[36:39], v248, s[36:39], s64 offen sc1
    s_add_u32 s64, s64, 4096
    buffer_load_dwordx4 v[40:43], v248, s[36:39], s64 offen sc1
    s_add_u32 s64, s64, 4096
    buffer_load_dwordx4 v[44:47], v248, s[36:39], s64 offen sc1
    s_add_u32 s64, s64, 4096
    buffer_load_dwordx4 v[48:51], v248, s[36:39], s64 offen sc1
    s_add_u32 s64, s64, 4096
    buffer_load_dwordx4 v[52:55], v248, s[36:39], s64 offen sc1
    s_add_u32 s64, s64, 4096
    buffer_load_dwordx4 v[56:59], v248, s[36:39], s64 offen sc1
    s_add_u32 s64, s64, 4096
    buffer_load_dwordx4 v[60:63], v248, s[36:39], s64 offen sc1
    buffer_load_dwordx4 v[152:155], v249, s[40:43], s10 offen
    buffer_load_dwordx2 v[156:157], v250, s[36:39], s11 offen sc1
    buffer_load_dwordx4 v[158:161], v249, s[40:43], s52 offen
    buffer_load_dwordx2 v[162:163], v250, s[36:39], s53 offen sc1
    v_mov_b32 v2, 0
    buffer_atomic_add v2, v253, s[36:39], s54 offen sc0 sc1
    s_waitcnt vmcnt(0)
    v_readfirstlane_b32 s3, v2
    s_nop 0
    s_cmp_ge_u32 s3, 12
    s_cselect_b32 s49, 1, 0
    s_cbranch_scc0 L_reah0
    s_mov_b32 s64, s50
    buffer_load_dwordx4 v[64:67], v248, s[36:39], s64 offen sc1
    s_add_u32 s64, s64, 4096
    buffer_load_dwordx4 v[68:71], v248, s[36:39], s64 offen sc1
    s_add_u32 s64, s64, 4096
    buffer_load_dwordx4 v[72:75], v248, s[36:39], s64 offen sc1
    s_add_u32 s64, s64, 4096
    buffer_load_dwordx4 v[76:79], v248, s[36:39], s64 offen sc1
    s_add_u32 s64, s64, 4096
    buffer_load_dwordx4 v[80:83], v248, s[36:39], s64 offen sc1
    s_add_u32 s64, s64, 4096
    buffer_load_dwordx4 v[84:87], v248, s[36:39], s64 offen sc1
    s_add_u32 s64, s64, 4096
    buffer_load_dwordx4 v[88:91], v248, s[36:39], s64 offen sc1
    s_add_u32 s64, s64, 4096
    buffer_load_dwordx4 v[92:95], v248, s[36:39], s64 offen sc1
    s_add_u32 s64, s64, 4096
    buffer_load_dwordx4 v[96:99], v248, s[36:39], s64 offen sc1
    s_add_u32 s64, s64, 4096
    buffer_load_dwordx4 v[100:103], v248, s[36:39], s64 offen sc1
    s_add_u32 s64, s64, 4096
    buffer_load_dwordx4 v[104:107], v248, s[36:39], s64 offen sc1
    s_add_u32 s64, s64, 4096
    buffer_load_dwordx4 v[108:111], v248, s[36:39], s64 offen sc1
L_reah0:
    v_lshlrev_b32 v112, 16, v16
    v_and_b32 v113, s35, v16
    v_lshlrev_b32 v114, 16, v17
    v_and_b32 v115, s35, v17
    v_lshlrev_b32 v116, 16, v18
    v_and_b32 v117, s35, v18
    v_lshlrev_b32 v118, 16, v19
    v_and_b32 v119, s35, v19
    v_lshlrev_b32 v224, 16, v20
    v_and_b32 v225, s35, v20
    v_lshlrev_b32 v226, 16, v21
    v_and_b32 v227, s35, v21
    v_lshlrev_b32 v228, 16, v22
    v_and_b32 v229, s35, v22
    v_lshlrev_b32 v230, 16, v23
    v_and_b32 v231, s35, v23
    v_pk_add_f32 v[112:113], v[112:113], v[224:225]
    v_pk_add_f32 v[114:115], v[114:115], v[226:227]
    v_pk_add_f32 v[116:117], v[116:117], v[228:229]
    v_pk_add_f32 v[118:119], v[118:119], v[230:231]
    v_lshlrev_b32 v224, 16, v24
    v_and_b32 v225, s35, v24
    v_lshlrev_b32 v226, 16, v25
    v_and_b32 v227, s35, v25
    v_lshlrev_b32 v228, 16, v26
    v_and_b32 v229, s35, v26
    v_lshlrev_b32 v230, 16, v27
    v_and_b32 v231, s35, v27
    v_pk_add_f32 v[112:113], v[112:113], v[224:225]
    v_pk_add_f32 v[114:115], v[114:115], v[226:227]
    v_pk_add_f32 v[116:117], v[116:117], v[228:229]
    v_pk_add_f32 v[118:119], v[118:119], v[230:231]
    v_lshlrev_b32 v224, 16, v28
    v_and_b32 v225, s35, v28
    v_lshlrev_b32 v226, 16, v29
    v_and_b32 v227, s35, v29
    v_lshlrev_b32 v228, 16, v30
    v_and_b32 v229, s35, v30
    v_lshlrev_b32 v230, 16, v31
    v_and_b32 v231, s35, v31
    v_pk_add_f32 v[112:113], v[112:113], v[224:225]
    v_pk_add_f32 v[114:115], v[114:115], v[226:227]
    v_pk_add_f32 v[116:117], v[116:117], v[228:229]
    v_pk_add_f32 v[118:119], v[118:119], v[230:231]
    v_lshlrev_b32 v224, 16, v32
    v_and_b32 v225, s35, v32
    v_lshlrev_b32 v226, 16, v33
    v_and_b32 v227, s35, v33
    v_lshlrev_b32 v228, 16, v34
    v_and_b32 v229, s35, v34
    v_lshlrev_b32 v230, 16, v35
    v_and_b32 v231, s35, v35
    v_pk_add_f32 v[112:113], v[112:113], v[224:225]
    v_pk_add_f32 v[114:115], v[114:115], v[226:227]
    v_pk_add_f32 v[116:117], v[116:117], v[228:229]
    v_pk_add_f32 v[118:119], v[118:119], v[230:231]
    v_lshlrev_b32 v224, 16, v36
    v_and_b32 v225, s35, v36
    v_lshlrev_b32 v226, 16, v37
    v_and_b32 v227, s35, v37
    v_lshlrev_b32 v228, 16, v38
    v_and_b32 v229, s35, v38
    v_lshlrev_b32 v230, 16, v39
    v_and_b32 v231, s35, v39
    v_pk_add_f32 v[112:113], v[112:113], v[224:225]
    v_pk_add_f32 v[114:115], v[114:115], v[226:227]
    v_pk_add_f32 v[116:117], v[116:117], v[228:229]
    v_pk_add_f32 v[118:119], v[118:119], v[230:231]
    v_lshlrev_b32 v224, 16, v40
    v_and_b32 v225, s35, v40
    v_lshlrev_b32 v226, 16, v41
    v_and_b32 v227, s35, v41
    v_lshlrev_b32 v228, 16, v42
    v_and_b32 v229, s35, v42
    v_lshlrev_b32 v230, 16, v43
    v_and_b32 v231, s35, v43
    v_pk_add_f32 v[112:113], v[112:113], v[224:225]
    v_pk_add_f32 v[114:115], v[114:115], v[226:227]
    v_pk_add_f32 v[116:117], v[116:117], v[228:229]
    v_pk_add_f32 v[118:119], v[118:119], v[230:231]
    v_lshlrev_b32 v224, 16, v44
    v_and_b32 v225, s35, v44
    v_lshlrev_b32 v226, 16, v45
    v_and_b32 v227, s35, v45
    v_lshlrev_b32 v228, 16, v46
    v_and_b32 v229, s35, v46
    v_lshlrev_b32 v230, 16, v47
    v_and_b32 v231, s35, v47
    v_pk_add_f32 v[112:113], v[112:113], v[224:225]
    v_pk_add_f32 v[114:115], v[114:115], v[226:227]
    v_pk_add_f32 v[116:117], v[116:117], v[228:229]
    v_pk_add_f32 v[118:119], v[118:119], v[230:231]
    v_lshlrev_b32 v224, 16, v48
    v_and_b32 v225, s35, v48
    v_lshlrev_b32 v226, 16, v49
    v_and_b32 v227, s35, v49
    v_lshlrev_b32 v228, 16, v50
    v_and_b32 v229, s35, v50
    v_lshlrev_b32 v230, 16, v51
    v_and_b32 v231, s35, v51
    v_pk_add_f32 v[112:113], v[112:113], v[224:225]
    v_pk_add_f32 v[114:115], v[114:115], v[226:227]
    v_pk_add_f32 v[116:117], v[116:117], v[228:229]
    v_pk_add_f32 v[118:119], v[118:119], v[230:231]
    v_lshlrev_b32 v224, 16, v52
    v_and_b32 v225, s35, v52
    v_lshlrev_b32 v226, 16, v53
    v_and_b32 v227, s35, v53
    v_lshlrev_b32 v228, 16, v54
    v_and_b32 v229, s35, v54
    v_lshlrev_b32 v230, 16, v55
    v_and_b32 v231, s35, v55
    v_pk_add_f32 v[112:113], v[112:113], v[224:225]
    v_pk_add_f32 v[114:115], v[114:115], v[226:227]
    v_pk_add_f32 v[116:117], v[116:117], v[228:229]
    v_pk_add_f32 v[118:119], v[118:119], v[230:231]
    v_lshlrev_b32 v224, 16, v56
    v_and_b32 v225, s35, v56
    v_lshlrev_b32 v226, 16, v57
    v_and_b32 v227, s35, v57
    v_lshlrev_b32 v228, 16, v58
    v_and_b32 v229, s35, v58
    v_lshlrev_b32 v230, 16, v59
    v_and_b32 v231, s35, v59
    v_pk_add_f32 v[112:113], v[112:113], v[224:225]
    v_pk_add_f32 v[114:115], v[114:115], v[226:227]
    v_pk_add_f32 v[116:117], v[116:117], v[228:229]
    v_pk_add_f32 v[118:119], v[118:119], v[230:231]
    v_lshlrev_b32 v224, 16, v60
    v_and_b32 v225, s35, v60
    v_lshlrev_b32 v226, 16, v61
    v_and_b32 v227, s35, v61
    v_lshlrev_b32 v228, 16, v62
    v_and_b32 v229, s35, v62
    v_lshlrev_b32 v230, 16, v63
    v_and_b32 v231, s35, v63
    v_pk_add_f32 v[112:113], v[112:113], v[224:225]
    v_pk_add_f32 v[114:115], v[114:115], v[226:227]
    v_pk_add_f32 v[116:117], v[116:117], v[228:229]
    v_pk_add_f32 v[118:119], v[118:119], v[230:231]
    s_cmp_eq_u32 s49, 1
    s_cbranch_scc1 L_rebh0
L_resh1:
    v_mov_b32 v2, 0
    buffer_atomic_add v2, v253, s[36:39], s54 offen sc0 sc1
    s_waitcnt vmcnt(0)
    v_readfirstlane_b32 s3, v2
    s_nop 0
    s_cmp_ge_u32 s3, 12
    s_cbranch_scc1 L_reth1
    s_sleep 4
    s_sub_u32 s74, s74, 1
    s_cbranch_scc0 L_resh1
    s_mov_b32 s74, 0
L_reth1:
    s_mov_b32 s64, s50
    buffer_load_dwordx4 v[64:67], v248, s[36:39], s64 offen sc1
    s_add_u32 s64, s64, 4096
    buffer_load_dwordx4 v[68:71], v248, s[36:39], s64 offen sc1
    s_add_u32 s64, s64, 4096
    buffer_load_dwordx4 v[72:75], v248, s[36:39], s64 offen sc1
    s_add_u32 s64, s64, 4096
    buffer_load_dwordx4 v[76:79], v248, s[36:39], s64 offen sc1
    s_add_u32 s64, s64, 4096
    buffer_load_dwordx4 v[80:83], v248, s[36:39], s64 offen sc1
    s_add_u32 s64, s64, 4096
    buffer_load_dwordx4 v[84:87], v248, s[36:39], s64 offen sc1
    s_add_u32 s64, s64, 4096
    buffer_load_dwordx4 v[88:91], v248, s[36:39], s64 offen sc1
    s_add_u32 s64, s64, 4096
    buffer_load_dwordx4 v[92:95], v248, s[36:39], s64 offen sc1
    s_add_u32 s64, s64, 4096
    buffer_load_dwordx4 v[96:99], v248, s[36:39], s64 offen sc1
    s_add_u32 s64, s64, 4096
    buffer_load_dwordx4 v[100:103], v248, s[36:39], s64 offen sc1
    s_add_u32 s64, s64, 4096
    buffer_load_dwordx4 v[104:107], v248, s[36:39], s64 offen sc1
    s_add_u32 s64, s64, 4096
    buffer_load_dwordx4 v[108:111], v248, s[36:39], s64 offen sc1
L_rebh0:
L_reyh:
    buffer_load_dword v4, v254, s[36:39], s14 offen sc1
    buffer_load_dword v5, v254, s[36:39], s56 offen sc1
    s_waitcnt vmcnt(0)
    v_min_u32 v4, v4, v5
    v_cmp_le_u32 vcc, 1, v4
    s_nop 0
    s_cmp_eq_u32 vcc_lo, 0xff
    s_cbranch_scc1 L_reydh
    s_sleep 4
    s_sub_u32 s74, s74, 1
    s_cbranch_scc0 L_reyh
    s_mov_b32 s74, 0
L_reydh:
    buffer_load_dwordx4 v[184:187], v248, s[36:39], s9 offen offset:0 sc1
    buffer_load_dwordx4 v[188:191], v248, s[36:39], s9 offen offset:1024 sc1
    buffer_load_dwordx4 v[192:195], v248, s[36:39], s51 offen offset:0 sc1
    buffer_load_dwordx4 v[196:199], v248, s[36:39], s51 offen offset:1024 sc1
    v_lshlrev_b32 v120, 16, v64
    v_and_b32 v121, s35, v64
    v_lshlrev_b32 v122, 16, v65
    v_and_b32 v123, s35, v65
    v_lshlrev_b32 v124, 16, v66
    v_and_b32 v125, s35, v66
    v_lshlrev_b32 v126, 16, v67
    v_and_b32 v127, s35, v67
    v_lshlrev_b32 v224, 16, v68
    v_and_b32 v225, s35, v68
    v_lshlrev_b32 v226, 16, v69
    v_and_b32 v227, s35, v69
    v_lshlrev_b32 v228, 16, v70
    v_and_b32 v229, s35, v70
    v_lshlrev_b32 v230, 16, v71
    v_and_b32 v231, s35, v71
    v_pk_add_f32 v[120:121], v[120:121], v[224:225]
    v_pk_add_f32 v[122:123], v[122:123], v[226:227]
    v_pk_add_f32 v[124:125], v[124:125], v[228:229]
    v_pk_add_f32 v[126:127], v[126:127], v[230:231]
    v_lshlrev_b32 v224, 16, v72
    v_and_b32 v225, s35, v72
    v_lshlrev_b32 v226, 16, v73
    v_and_b32 v227, s35, v73
    v_lshlrev_b32 v228, 16, v74
    v_and_b32 v229, s35, v74
    v_lshlrev_b32 v230, 16, v75
    v_and_b32 v231, s35, v75
    v_pk_add_f32 v[120:121], v[120:121], v[224:225]
    v_pk_add_f32 v[122:123], v[122:123], v[226:227]
    v_pk_add_f32 v[124:125], v[124:125], v[228:229]
    v_pk_add_f32 v[126:127], v[126:127], v[230:231]
    v_lshlrev_b32 v224, 16, v76
    v_and_b32 v225, s35, v76
    v_lshlrev_b32 v226, 16, v77
    v_and_b32 v227, s35, v77
    v_lshlrev_b32 v228, 16, v78
    v_and_b32 v229, s35, v78
    v_lshlrev_b32 v230, 16, v79
    v_and_b32 v231, s35, v79
    v_pk_add_f32 v[120:121], v[120:121], v[224:225]
    v_pk_add_f32 v[122:123], v[122:123], v[226:227]
    v_pk_add_f32 v[124:125], v[124:125], v[228:229]
    v_pk_add_f32 v[126:127], v[126:127], v[230:231]
    v_lshlrev_b32 v224, 16, v80
    v_and_b32 v225, s35, v80
    v_lshlrev_b32 v226, 16, v81
    v_and_b32 v227, s35, v81
    v_lshlrev_b32 v228, 16, v82
    v_and_b32 v229, s35, v82
    v_lshlrev_b32 v230, 16, v83
    v_and_b32 v231, s35, v83
    v_pk_add_f32 v[120:121], v[120:121], v[224:225]
    v_pk_add_f32 v[122:123], v[122:123], v[226:227]
    v_pk_add_f32 v[124:125], v[124:125], v[228:229]
    v_pk_add_f32 v[126:127], v[126:127], v[230:231]
    v_lshlrev_b32 v224, 16, v84
    v_and_b32 v225, s35, v84
    v_lshlrev_b32 v226, 16, v85
    v_and_b32 v227, s35, v85
    v_lshlrev_b32 v228, 16, v86
    v_and_b32 v229, s35, v86
    v_lshlrev_b32 v230, 16, v87
    v_and_b32 v231, s35, v87
    v_pk_add_f32 v[120:121], v[120:121], v[224:225]
    v_pk_add_f32 v[122:123], v[122:123], v[226:227]
    v_pk_add_f32 v[124:125], v[124:125], v[228:229]
    v_pk_add_f32 v[126:127], v[126:127], v[230:231]
    v_lshlrev_b32 v224, 16, v88
    v_and_b32 v225, s35, v88
    v_lshlrev_b32 v226, 16, v89
    v_and_b32 v227, s35, v89
    v_lshlrev_b32 v228, 16, v90
    v_and_b32 v229, s35, v90
    v_lshlrev_b32 v230, 16, v91
    v_and_b32 v231, s35, v91
    v_pk_add_f32 v[120:121], v[120:121], v[224:225]
    v_pk_add_f32 v[122:123], v[122:123], v[226:227]
    v_pk_add_f32 v[124:125], v[124:125], v[228:229]
    v_pk_add_f32 v[126:127], v[126:127], v[230:231]
    v_lshlrev_b32 v224, 16, v92
    v_and_b32 v225, s35, v92
    v_lshlrev_b32 v226, 16, v93
    v_and_b32 v227, s35, v93
    v_lshlrev_b32 v228, 16, v94
    v_and_b32 v229, s35, v94
    v_lshlrev_b32 v230, 16, v95
    v_and_b32 v231, s35, v95
    v_pk_add_f32 v[120:121], v[120:121], v[224:225]
    v_pk_add_f32 v[122:123], v[122:123], v[226:227]
    v_pk_add_f32 v[124:125], v[124:125], v[228:229]
    v_pk_add_f32 v[126:127], v[126:127], v[230:231]
    v_lshlrev_b32 v224, 16, v96
    v_and_b32 v225, s35, v96
    v_lshlrev_b32 v226, 16, v97
    v_and_b32 v227, s35, v97
    v_lshlrev_b32 v228, 16, v98
    v_and_b32 v229, s35, v98
    v_lshlrev_b32 v230, 16, v99
    v_and_b32 v231, s35, v99
    v_pk_add_f32 v[120:121], v[120:121], v[224:225]
    v_pk_add_f32 v[122:123], v[122:123], v[226:227]
    v_pk_add_f32 v[124:125], v[124:125], v[228:229]
    v_pk_add_f32 v[126:127], v[126:127], v[230:231]
    v_lshlrev_b32 v224, 16, v100
    v_and_b32 v225, s35, v100
    v_lshlrev_b32 v226, 16, v101
    v_and_b32 v227, s35, v101
    v_lshlrev_b32 v228, 16, v102
    v_and_b32 v229, s35, v102
    v_lshlrev_b32 v230, 16, v103
    v_and_b32 v231, s35, v103
    v_pk_add_f32 v[120:121], v[120:121], v[224:225]
    v_pk_add_f32 v[122:123], v[122:123], v[226:227]
    v_pk_add_f32 v[124:125], v[124:125], v[228:229]
    v_pk_add_f32 v[126:127], v[126:127], v[230:231]
    v_lshlrev_b32 v224, 16, v104
    v_and_b32 v225, s35, v104
    v_lshlrev_b32 v226, 16, v105
    v_and_b32 v227, s35, v105
    v_lshlrev_b32 v228, 16, v106
    v_and_b32 v229, s35, v106
    v_lshlrev_b32 v230, 16, v107
    v_and_b32 v231, s35, v107
    v_pk_add_f32 v[120:121], v[120:121], v[224:225]
    v_pk_add_f32 v[122:123], v[122:123], v[226:227]
    v_pk_add_f32 v[124:125], v[124:125], v[228:229]
    v_pk_add_f32 v[126:127], v[126:127], v[230:231]
    v_lshlrev_b32 v224, 16, v108
    v_and_b32 v225, s35, v108
    v_lshlrev_b32 v226, 16, v109
    v_and_b32 v227, s35, v109
    v_lshlrev_b32 v228, 16, v110
    v_and_b32 v229, s35, v110
    v_lshlrev_b32 v230, 16, v111
    v_and_b32 v231, s35, v111
    v_pk_add_f32 v[120:121], v[120:121], v[224:225]
    v_pk_add_f32 v[122:123], v[122:123], v[226:227]
    v_pk_add_f32 v[124:125], v[124:125], v[228:229]
    v_pk_add_f32 v[126:127], v[126:127], v[230:231]
    s_waitcnt vmcnt(2)
    v_permlane16_swap_b32 v152, v154
    v_permlane16_swap_b32 v153, v155
    v_perm_b32 v184, v184, v184, s13
    v_perm_b32 v185, v185, v185, s13
    v_perm_b32 v186, v186, v186, s13
    v_perm_b32 v187, v187, v187, s13
    v_perm_b32 v188, v188, v188, s13
    v_perm_b32 v189, v189, v189, s13
    v_perm_b32 v190, v190, v190, s13
    v_perm_b32 v191, v191, v191, s13
    v_lshlrev_b32 v224, 16, v152
    v_and_b32 v225, s35, v152
    v_sub_f32 v226, v224, v156
    v_sub_f32 v227, v225, v156
    v_mul_f32 v226, v226, v157
    v_mul_f32 v227, v227, v157
    v_fma_f32 v184, v226, v184, v224
    v_fma_f32 v185, v227, v185, v225
    v_lshlrev_b32 v224, 16, v153
    v_and_b32 v225, s35, v153
    v_sub_f32 v226, v224, v156
    v_sub_f32 v227, v225, v156
    v_mul_f32 v226, v226, v157
    v_mul_f32 v227, v227, v157
    v_fma_f32 v186, v226, v186, v224
    v_fma_f32 v187, v227, v187, v225
    v_lshlrev_b32 v224, 16, v154
    v_and_b32 v225, s35, v154
    v_sub_f32 v226, v224, v156
    v_sub_f32 v227, v225, v156
    v_mul_f32 v226, v226, v157
    v_mul_f32 v227, v227, v157
    v_fma_f32 v188, v226, v188, v224
    v_fma_f32 v189, v227, v189, v225
    v_lshlrev_b32 v224, 16, v155
    v_and_b32 v225, s35, v155
    v_sub_f32 v226, v224, v156
    v_sub_f32 v227, v225, v156
    v_mul_f32 v226, v226, v157
    v_mul_f32 v227, v227, v157
    v_fma_f32 v190, v226, v190, v224
    v_fma_f32 v191, v227, v191, v225
    v_fmac_f32 v184, v112, v157
    v_fmac_f32 v185, v113, v157
    v_fmac_f32 v186, v114, v157
    v_fmac_f32 v187, v115, v157
    v_fmac_f32 v188, v116, v157
    v_fmac_f32 v189, v117, v157
    v_fmac_f32 v190, v118, v157
    v_fmac_f32 v191, v119, v157
    v_cvt_pk_bf16_f32 v112, v184, v185
    v_cvt_pk_bf16_f32 v113, v186, v187
    v_cvt_pk_bf16_f32 v114, v188, v189
    v_cvt_pk_bf16_f32 v115, v190, v191
    s_nop 1
    v_permlane16_swap_b32 v112, v114
    v_permlane16_swap_b32 v113, v115
    ds_bpermute_b32 v16, v252, v112
    ds_bpermute_b32 v17, v252, v113
    ds_bpermute_b32 v18, v252, v114
    ds_bpermute_b32 v19, v252, v115
    s_waitcnt vmcnt(0)
    v_permlane16_swap_b32 v158, v160
    v_permlane16_swap_b32 v159, v161
    v_perm_b32 v192, v192, v192, s55
    v_perm_b32 v193, v193, v193, s55
    v_perm_b32 v194, v194, v194, s55
    v_perm_b32 v195, v195, v195, s55
    v_perm_b32 v196, v196, v196, s55
    v_perm_b32 v197, v197, v197, s55
    v_perm_b32 v198, v198, v198, s55
    v_perm_b32 v199, v199, v199, s55
    v_lshlrev_b32 v224, 16, v158
    v_and_b32 v225, s35, v158
    v_sub_f32 v226, v224, v162
    v_sub_f32 v227, v225, v162
    v_mul_f32 v226, v226, v163
    v_mul_f32 v227, v227, v163
    v_fma_f32 v192, v226, v192, v224
    v_fma_f32 v193, v227, v193, v225
    v_lshlrev_b32 v224, 16, v159
    v_and_b32 v225, s35, v159
    v_sub_f32 v226, v224, v162
    v_sub_f32 v227, v225, v162
    v_mul_f32 v226, v226, v163
    v_mul_f32 v227, v227, v163
    v_fma_f32 v194, v226, v194, v224
    v_fma_f32 v195, v227, v195, v225
    v_lshlrev_b32 v224, 16, v160
    v_and_b32 v225, s35, v160
    v_sub_f32 v226, v224, v162
    v_sub_f32 v227, v225, v162
    v_mul_f32 v226, v226, v163
    v_mul_f32 v227, v227, v163
    v_fma_f32 v196, v226, v196, v224
    v_fma_f32 v197, v227, v197, v225
    v_lshlrev_b32 v224, 16, v161
    v_and_b32 v225, s35, v161
    v_sub_f32 v226, v224, v162
    v_sub_f32 v227, v225, v162
    v_mul_f32 v226, v226, v163
    v_mul_f32 v227, v227, v163
    v_fma_f32 v198, v226, v198, v224
    v_fma_f32 v199, v227, v199, v225
    v_fmac_f32 v192, v120, v163
    v_fmac_f32 v193, v121, v163
    v_fmac_f32 v194, v122, v163
    v_fmac_f32 v195, v123, v163
    v_fmac_f32 v196, v124, v163
    v_fmac_f32 v197, v125, v163
    v_fmac_f32 v198, v126, v163
    v_fmac_f32 v199, v127, v163
    v_cvt_pk_bf16_f32 v120, v192, v193
    v_cvt_pk_bf16_f32 v121, v194, v195
    v_cvt_pk_bf16_f32 v122, v196, v197
    v_cvt_pk_bf16_f32 v123, v198, v199
    s_nop 1
    v_permlane16_swap_b32 v120, v122
    v_permlane16_swap_b32 v121, v123
    ds_bpermute_b32 v20, v252, v120
    ds_bpermute_b32 v21, v252, v121
    ds_bpermute_b32 v22, v252, v122
    ds_bpermute_b32 v23, v252, v123
    s_waitcnt lgkmcnt(4)
    buffer_store_dwordx4 v[16:19], v251, s[60:63], s10 offen sc1
    s_waitcnt lgkmcnt(0)
    buffer_store_dwordx4 v[20:23], v251, s[60:63], s52 offen sc1
    s_branch L_rlx
L_earlc:
    s_cmp_eq_u32 s6, 0
    s_cbranch_scc1 L_nxt
    s_barrier
L_nxt:
    s_branch L_rlx
L_mexit:
    s_endpgm
.section .rodata,"a"
.p2align 6
.amdhsa_kernel parallel_sum__ssm_conv_h3__dense_activation_relu__prompt_kernel
  .amdhsa_next_free_vgpr 256
  .amdhsa_next_free_sgpr 102
  .amdhsa_accum_offset 256
  .amdhsa_group_segment_fixed_size 0
  .amdhsa_kernarg_size 96
  .amdhsa_user_sgpr_count 2
  .amdhsa_user_sgpr_kernarg_segment_ptr 1
  .amdhsa_system_sgpr_workgroup_id_x 1
.end_amdhsa_kernel
```
